```python
import torch

def _softmax(x, axis=-1):
    return torch.softmax(x, dim=axis)

def _gelu(x):
    return torch.nn.functional.gelu(x, approximate='tanh')

def _silu(x):
    return torch.nn.functional.silu(x)

def _sigmoid(x):
    return torch.sigmoid(x)

def _layernorm(x, axis=-1, eps=1e-05):
    m = x.mean(dim=axis, keepdim=True)
    v = x.var(dim=axis, keepdim=True, unbiased=False)
    return (x - m) / torch.sqrt(v + eps)

def _scatter_add(tgt, idx, src, axis=0):
    return tgt.clone().index_add_(axis, idx, src)

def _segment_sum(src, seg, n):
    out = torch.zeros((n,) + src.shape[1:], dtype=src.dtype)
    return out.index_add_(0, seg, src)

def _pad(x, pw):
    flat = tuple((v for pair in reversed(pw) for v in pair))
    return torch.nn.functional.pad(x, flat)
kernel_name = 'adaLN_cond__sliding_block_cached__geglu_ffn__decode'

def setup_inputs():

    _w = lambda a: (lambda t: t.to(torch.bfloat16) if t.is_floating_point() else t)(torch.as_tensor(a))

    def _A_setup():
        B, Sq, D = (2, 1, 640)
        Hq, Hkv, Sk, Dh = (32, 32, 4096, 192)
        assert Hq % Hkv == 0, (Hq, Hkv)
        return {'x': _w((lambda *s: torch.randn(*s, dtype=torch.bfloat16) * 0.05)(B, Sq, D)), 'k_cache': _w((lambda *s: torch.randn(*s, dtype=torch.bfloat16) * 3.2)(B, Hkv, Sk, Dh)), 'v_cache': _w((lambda *s: torch.randn(*s, dtype=torch.bfloat16) * 0.4)(B, Hkv, Sk, Dh)), 'wq': _w((lambda *s: torch.randn(*s, dtype=torch.bfloat16) * 3.2)(D, Hq * Dh) * D ** (-0.5)), 'wo': _w((lambda *s: torch.randn(*s, dtype=torch.bfloat16) * 0.4)(Hq * Dh, D) * (Hq * Dh) ** (-0.5))}
    _A_in = _A_setup()

    def _B_setup():
        B, S, D, F = (2, 1, 640, 1536)
        return {'x': _w((lambda *s: torch.randn(*s, dtype=torch.bfloat16) * 0.05)(B, S, D)), 'w_gate': _w((lambda *s: torch.randn(*s, dtype=torch.bfloat16) * 0.05)(D, F)), 'w_up': _w((lambda *s: torch.randn(*s, dtype=torch.bfloat16) * 0.05)(D, F)), 'w_down': _w((lambda *s: torch.randn(*s, dtype=torch.bfloat16) * 0.05)(F, D))}
    _B_in = _B_setup()
    return {'A_x': _A_in['x'], 'A_k_cache': _A_in['k_cache'], 'A_v_cache': _A_in['v_cache'], 'A_wq': _A_in['wq'], 'A_wo': _A_in['wo'], 'B_x': _B_in['x'], 'B_w_gate': _B_in['w_gate'], 'B_w_up': _B_in['w_up'], 'B_w_down': _B_in['w_down'], 'c': _w((lambda *s: torch.randn(*s, dtype=torch.bfloat16) * 0.1)(2, 640) * 8.0), 'w_mod': _w((lambda *s: torch.randn(*s, dtype=torch.bfloat16) * 0.1)(640, 6 * 640) * 640 ** (-0.5) * 8.0)}

def reference(A_x, A_k_cache, A_v_cache, A_wq, A_wo, B_x, B_w_gate, B_w_up, B_w_down, c, w_mod):

    def _A_ref(x, k_cache, v_cache, wq, wo):
        B, Sq, D = x.shape
        Hq, Dh = (32, 192)
        Hkv, Sk = (k_cache.shape[1], k_cache.shape[2])
        W = min(4096, max(256, Sk // 4))
        rep = Hq // Hkv
        q = (lambda x, *d: x.permute(*d))((x @ wq).reshape(B, Sq, Hq, Dh), 0, 2, 1, 3)
        k = (lambda x, n, axis: torch.repeat_interleave(x, n, dim=axis))(k_cache[:, :, Sk - W:, :], rep, axis=1)
        v = (lambda x, n, axis: torch.repeat_interleave(x, n, dim=axis))(v_cache[:, :, Sk - W:, :], rep, axis=1)
        scores = torch.einsum('bhqd,bhkd->bhqk', q, k) * Dh ** (-0.5)
        p = _softmax(scores, axis=-1)
        o = torch.einsum('bhqk,bhkd->bhqd', p, v)
        return (lambda x, *d: x.permute(*d))(o, 0, 2, 1, 3).reshape(B, Sq, Hq * Dh) @ wo

    def _B_ref(x, w_gate, w_up, w_down):
        return _gelu(x @ w_gate) * (x @ w_up) @ w_down
    x = A_x
    mod = (_silu(c) @ w_mod).reshape(c.shape[0], 6, 1, -1)
    sa, ca, ga, sb, cb, gb = (mod[:, 0].clone(), mod[:, 1].clone(), mod[:, 2].clone(), mod[:, 3].clone(), mod[:, 4].clone(), mod[:, 5].clone())
    h = _layernorm(x, axis=-1) * (1 + ca) + sa
    x = x + ga * _A_ref(h, A_k_cache, A_v_cache, A_wq, A_wo)
    h = _layernorm(x, axis=-1) * (1 + cb) + sb
    x = x + gb * _B_ref(h, B_w_gate, B_w_up, B_w_down)
    return x
```

```asm
; @launch grid=(256,1,1) block=(768,1,1) lds=160256
.amdgcn_target "amdgcn-amd-amdhsa--gfx950"
.text
.globl adaLN_cond__sliding_block_cached__geglu_ffn__decode_kernel
.p2align 8
.type adaLN_cond__sliding_block_cached__geglu_ffn__decode_kernel,@function
adaLN_cond__sliding_block_cached__geglu_ffn__decode_kernel:
    s_cmp_ge_u32 s2, 256
    s_cbranch_scc1 L_END
    s_load_dwordx16 s[8:23], s[0:1], 0
    s_load_dwordx8 s[24:31], s[0:1], 64
    s_load_dwordx4 s[32:35], s[0:1], 96
    v_lshrrev_b32 v1, 6, v0
    v_and_b32 v0, 63, v0
    s_getpc_b64 s[56:57]
.Lpcref:
    s_lshr_b32 s5, s2, 3
    v_readfirstlane_b32 s3, v1
    s_sub_u32 s56, s56, .Lpcref-adaLN_cond__sliding_block_cached__geglu_ffn__decode_kernel
    s_subb_u32 s57, s57, 0
    s_and_b32 s4, s2, 7
    s_cmp_ge_u32 s3, 2
    s_cbranch_scc1 L_NOPF
    s_mul_i32 s6, s5, 2
    s_add_u32 s6, s6, s3
    s_mul_i32 s7, s6, 3856
    s_lshr_b32 s7, s7, 16
    s_mul_i32 s7, s7, 17
    s_sub_u32 s6, s6, s7
    s_lshl_b32 s6, s6, 10
    v_lshl_add_u32 v2, v0, 4, s6
    global_load_dwordx4 v[152:155], v2, s[56:57]
    s_nop 0
L_NOPF:
    v_mov_b32 v160, 135488
    v_and_b32 v162, 3, v0
    v_add_u32 v162, 1, v162
    v_lshrrev_b32 v162, 2, v162
    v_mul_u32_u24 v162, 0xff, v162
    s_lshr_b32 s40, s5, 3
    s_lshl_b32 s41, s4, 2
    s_add_u32 s41, s41, s40
    s_mul_i32 s42, s5, 26
    s_lshr_b32 s42, s42, 8
    s_mul_i32 s43, s42, 10
    s_sub_u32 s43, s5, s43
    s_lshl_b32 s44, s2, 13
    s_lshr_b32 s45, s5, 2
    s_and_b32 s45, s45, 1
    s_and_b32 s46, s5, 7
    s_lshl_b32 s6, s45, 5
    s_add_u32 s6, s6, s41
    s_mul_i32 s47, s6, 1572864
    s_and_b32 s6, s5, 3
    s_mul_i32 s6, s6, 98304
    s_add_u32 s47, s47, s6
    s_add_u32 s47, s47, 1179648
    s_mov_b32 s48, 0xffff0000
    s_mov_b32 s49, 0
    s_mov_b32 s50, 0
    s_mov_b32 s51, 0x0000ffff
    s_mov_b32 s52, 0
    s_mov_b32 s53, 0xffff0000
    s_mov_b32 s75, 1
    s_mov_b32 s79, 63
    s_cmp_lt_u32 s3, 8
    s_cbranch_scc1 L_KWAVE
    s_cmp_eq_u32 s3, 9
    s_cbranch_scc1 L_CHAIN
    s_cmp_gt_u32 s3, 9
    s_cbranch_scc1 L_POST
    s_mov_b32 s78, 3
    s_setprio 2
    v_lshrrev_b32 v1, 3, v0
    v_and_b32 v2, 7, v0
    v_lshrrev_b32 v3, 1, v1
    v_and_b32 v3, 1, v3
    v_lshrrev_b32 v4, 1, v2
    v_xor_b32 v4, v4, v3
    v_lshlrev_b32 v4, 5, v4
    v_and_b32 v3, 1, v2
    v_lshlrev_b32 v3, 4, v3
    v_or_b32 v4, v4, v3
    v_mul_u32_u24 v10, 7680, v1
    v_add_u32 v10, v10, v4
    v_xor_b32 v11, 64, v10
    v_add_u32 v1, 0, v0
    v_mul_u32_u24 v2, 2731, v1
    v_lshrrev_b32 v2, 16, v2
    v_mul_u32_u24 v3, 24, v2
    v_sub_u32 v3, v1, v3
    v_lshrrev_b32 v4, 1, v2
    v_and_b32 v4, 1, v4
    v_lshrrev_b32 v1, 1, v3
    v_xor_b32 v1, v1, v4
    v_lshlrev_b32 v1, 5, v1
    v_and_b32 v3, 1, v3
    v_lshlrev_b32 v3, 4, v3
    v_or_b32 v1, v1, v3
    v_mul_u32_u24 v3, 12288, v2
    v_add_u32 v12, v3, v1
    v_xor_b32 v15, 64, v12
    v_add_u32 v1, 64, v0
    v_mul_u32_u24 v2, 2731, v1
    v_lshrrev_b32 v2, 16, v2
    v_mul_u32_u24 v3, 24, v2
    v_sub_u32 v3, v1, v3
    v_lshrrev_b32 v4, 1, v2
    v_and_b32 v4, 1, v4
    v_lshrrev_b32 v1, 1, v3
    v_xor_b32 v1, v1, v4
    v_lshlrev_b32 v1, 5, v1
    v_and_b32 v3, 1, v3
    v_lshlrev_b32 v3, 4, v3
    v_or_b32 v1, v1, v3
    v_mul_u32_u24 v3, 12288, v2
    v_add_u32 v13, v3, v1
    v_xor_b32 v16, 64, v13
    v_add_u32 v1, 128, v0
    v_mul_u32_u24 v2, 2731, v1
    v_lshrrev_b32 v2, 16, v2
    v_mul_u32_u24 v3, 24, v2
    v_sub_u32 v3, v1, v3
    v_lshrrev_b32 v4, 1, v2
    v_and_b32 v4, 1, v4
    v_lshrrev_b32 v1, 1, v3
    v_xor_b32 v1, v1, v4
    v_lshlrev_b32 v1, 5, v1
    v_and_b32 v3, 1, v3
    v_lshlrev_b32 v3, 4, v3
    v_or_b32 v1, v1, v3
    v_mul_u32_u24 v3, 12288, v2
    v_add_u32 v14, v3, v1
    v_xor_b32 v17, 64, v14
    s_and_b32 s6, s4, 3
    s_mul_i32 s84, s6, 1228800
    s_lshr_b32 s6, s4, 2
    s_mul_i32 s6, s6, 30
    s_add_u32 s6, s6, s5
    s_lshl_b32 s6, s6, 7
    s_add_u32 s84, s84, s6
    s_mul_i32 s87, s46, 983040
    s_mul_i32 s6, s41, 384
    s_add_u32 s87, s87, s6
    s_mov_b32 s85, 135680
    s_mov_b32 s86, 0
    s_waitcnt lgkmcnt(0)
    s_barrier
    s_mov_b32 s36, s34
    s_mov_b32 s37, s35
    s_mov_b32 s38, 2097280
    s_mov_b32 s39, 0x00020000
    s_mov_b32 s56, s28
    s_mov_b32 s57, s29
    s_mov_b32 s58, 4915200
    s_mov_b32 s59, 0x00020000
    s_mov_b32 s60, s14
    s_mov_b32 s61, s15
    s_mov_b32 s62, 7864320
    s_mov_b32 s63, 0x00020000
    s_cmp_lt_u32 s5, 30
    s_cbranch_scc1 L_LD_M
    s_mov_b32 s78, 9
    s_branch L_LD_Q0
L_LD_M:
    s_waitcnt vmcnt(31)
    s_mov_b32 m0, s85
    s_add_u32 s85, s85, 1024
    buffer_load_dwordx4 v10, s[56:59], s84 offen nt lds
    s_add_u32 s84, s84, 61440
    s_waitcnt vmcnt(31)
    s_mov_b32 m0, s85
    s_add_u32 s85, s85, 1024
    buffer_load_dwordx4 v11, s[56:59], s84 offen nt lds
    s_add_u32 s84, s84, 61440
    s_add_u32 s86, s86, 1
    s_cmp_lt_u32 s86, 10
    s_cbranch_scc1 L_LD_M
L_LD_Q0:
    s_mov_b32 s85, 98304
    s_mov_b32 s86, 0
    v_mov_b32 v161, 1
    ds_write_b32 v160, v161 offset:0
    s_nop 0
L_LD_Q:
    s_waitcnt vmcnt(31)
    s_mov_b32 m0, s85
    s_add_u32 s85, s85, 1024
    buffer_load_dwordx4 v12, s[60:63], s87 offen nt lds
    s_waitcnt vmcnt(31)
    s_mov_b32 m0, s85
    s_add_u32 s85, s85, 1024
    buffer_load_dwordx4 v13, s[60:63], s87 offen nt lds
    s_waitcnt vmcnt(31)
    s_mov_b32 m0, s85
    s_add_u32 s85, s85, 1024
    buffer_load_dwordx4 v14, s[60:63], s87 offen nt lds
    s_add_u32 s87, s87, 98304
    s_waitcnt vmcnt(31)
    s_mov_b32 m0, s85
    s_add_u32 s85, s85, 1024
    buffer_load_dwordx4 v15, s[60:63], s87 offen nt lds
    s_waitcnt vmcnt(31)
    s_mov_b32 m0, s85
    s_add_u32 s85, s85, 1024
    buffer_load_dwordx4 v16, s[60:63], s87 offen nt lds
    s_waitcnt vmcnt(31)
    s_mov_b32 m0, s85
    s_add_u32 s85, s85, 1024
    buffer_load_dwordx4 v17, s[60:63], s87 offen nt lds
    s_add_u32 s87, s87, 98304
    s_add_u32 s86, s86, 1
    s_cmp_eq_u32 s86, 2
    s_cbranch_scc0 L_LD_Q1
    s_waitcnt vmcnt(12)
    v_mov_b32 v161, 1
    ds_write_b32 v160, v161 offset:4
    s_nop 0
L_LD_Q1:
    s_cmp_lt_u32 s86, 5
    s_cbranch_scc1 L_LD_Q
    s_waitcnt vmcnt(0)
    v_mov_b32 v161, 1
    ds_write_b32 v160, v161 offset:8
    v_mov_b32 v9, 0x80000000
    v_mov_b32 v10, 0x80000000
    v_mov_b32 v11, 0x80000000
    v_mov_b32 v12, 0x80000000
    v_mov_b32 v13, 0x80000000
    v_mov_b32 v14, 0x80000000
    v_mov_b32 v15, 0x80000000
    v_mov_b32 v16, 0x80000000
    v_mov_b32 v17, 0x80000000
    v_mov_b32 v18, 0x80000000
    v_mov_b32 v19, 0x80000000
    v_mov_b32 v20, 0x80000000
    v_mov_b32 v21, 0x80000000
    v_mov_b32 v22, 0x80000000
    v_mov_b32 v23, 0x80000000
    v_mov_b32 v24, 0x80000000
    v_mov_b32 v25, 0x80000000
    v_mov_b32 v26, 0x80000000
    v_mov_b32 v27, 0x80000000
    v_mov_b32 v28, 0x80000000
    v_mov_b32 v29, 0x80000000
    s_mov_b32 s82, 0
    s_branch L_VLOAD
L_KWAVE:
    s_mov_b32 s78, 1
    s_cmp_lt_u32 s5, 30
    s_cbranch_scc1 L_K_ROLE
    s_mov_b32 s78, 2
L_K_ROLE:
    s_cmp_lg_u32 s3, 0
    s_cbranch_scc1 L_NOZ
    v_mov_b32 v2, 0
    v_lshlrev_b32 v3, 2, v0
    v_add_u32 v3, 135488, v3
    s_mov_b64 exec, 0xffff
    ds_write_b32 v3, v2
    s_mov_b64 exec, -1
L_NOZ:
    v_lshrrev_b32 v1, 3, v0
    v_mul_u32_u24 v1, 384, v1
    v_and_b32 v2, 7, v0
    v_lshlrev_b32 v2, 4, v2
    v_add_u32 v1, v1, v2
    s_mul_i32 s84, s3, 12288
    s_add_u32 s84, s84, s47
    s_waitcnt lgkmcnt(0)
    s_barrier
    s_mov_b32 s36, s34
    s_mov_b32 s37, s35
    s_mov_b32 s38, 2097280
    s_mov_b32 s39, 0x00020000
    s_mov_b32 s56, s10
    s_mov_b32 s57, s11
    s_mov_b32 s58, 100663296
    s_mov_b32 s59, 0x00020000
    s_mov_b32 s96, 0
SP_1:
    ds_read_b32 v161, v160 offset:0
    s_add_u32 s96, s96, 1
    s_waitcnt lgkmcnt(0)
    v_readfirstlane_b32 s97, v161
    s_nop 1
    s_cmp_ge_u32 s97, 1
    s_nop 0
    s_cbranch_scc1 SD_2
    s_cmp_gt_u32 s96, 1048576
    s_cbranch_scc1 SD_2
    s_sleep 1
    s_branch SP_1
SD_2:
    s_add_u32 s86, s84, 0
    buffer_load_dwordx4 v[8:11], v1, s[56:59], s86 offen offset:0 nt
    buffer_load_dwordx4 v[12:15], v1, s[56:59], s86 offen offset:128 nt
    buffer_load_dwordx4 v[16:19], v1, s[56:59], s86 offen offset:256 nt
    s_waitcnt vmcnt(2)
    s_add_u32 s86, s84, 3072
    buffer_load_dwordx4 v[20:23], v1, s[56:59], s86 offen offset:0 nt
    s_waitcnt vmcnt(2)
    buffer_load_dwordx4 v[24:27], v1, s[56:59], s86 offen offset:128 nt
    s_waitcnt vmcnt(2)
    buffer_load_dwordx4 v[28:31], v1, s[56:59], s86 offen offset:256 nt
    s_waitcnt vmcnt(2)
    s_add_u32 s86, s84, 6144
    buffer_load_dwordx4 v[32:35], v1, s[56:59], s86 offen offset:0 nt
    s_waitcnt vmcnt(2)
    buffer_load_dwordx4 v[36:39], v1, s[56:59], s86 offen offset:128 nt
    s_waitcnt vmcnt(2)
    buffer_load_dwordx4 v[40:43], v1, s[56:59], s86 offen offset:256 nt
    s_waitcnt vmcnt(2)
    s_add_u32 s86, s84, 9216
    buffer_load_dwordx4 v[44:47], v1, s[56:59], s86 offen offset:0 nt
    s_waitcnt vmcnt(2)
    buffer_load_dwordx4 v[48:51], v1, s[56:59], s86 offen offset:128 nt
    s_waitcnt vmcnt(2)
    buffer_load_dwordx4 v[52:55], v1, s[56:59], s86 offen offset:256 nt
    v_mov_b32 v161, 1
    s_mov_b64 exec, 1
    ds_add_u32 v160, v161 offset:52
    s_mov_b64 exec, -1
    s_waitcnt vmcnt(0)
    v_add_u32 v3, 132032, v2
    v_and_b32 v4, 7, v0
    v_lshlrev_b32 v4, 4, v4
    v_lshrrev_b32 v5, 3, v0
    v_lshlrev_b32 v5, 1, v5
    v_add_u32 v4, v4, v5
    s_lshl_b32 s6, s3, 6
    s_add_u32 s6, s6, 133440
    v_add_u32 v4, s6, v4
    s_lshl_b32 s6, s3, 3
    s_add_u32 s6, s6, 132416
    v_mov_b32 v5, s6
    s_mov_b32 s88, 0x02020202
    s_mov_b32 s89, 0x02020202
    s_mov_b32 s90, 0x04040404
    s_mov_b32 s91, 0x04040404
    s_mov_b32 s92, 0x08080808
    s_mov_b32 s93, 0x08080808
    s_mov_b32 s87, 0x3fb8aa3b
    s_mov_b32 s96, 0
SP_3:
    ds_read_b32 v161, v160 offset:16
    s_add_u32 s96, s96, 1
    s_waitcnt lgkmcnt(0)
    v_readfirstlane_b32 s97, v161
    s_nop 1
    s_cmp_ge_u32 s97, 1
    s_nop 0
    s_cbranch_scc1 SD_4
    s_cmp_gt_u32 s96, 1048576
    s_cbranch_scc1 SD_4
    s_sleep 3
    s_branch SP_3
SD_4:
    ds_read_b128 v[56:59], v3
    ds_read_b128 v[60:63], v3 offset:128
    ds_read_b128 v[64:67], v3 offset:256
    v_mov_b32 v68, 0
    v_mov_b32 v69, 0
    v_mov_b32 v70, 0
    v_mov_b32 v71, 0
    s_waitcnt lgkmcnt(0)
    v_dot2_f32_bf16 v68, v8, v56, v68
    v_dot2_f32_bf16 v69, v20, v56, v69
    v_dot2_f32_bf16 v70, v32, v56, v70
    v_dot2_f32_bf16 v71, v44, v56, v71
    v_dot2_f32_bf16 v68, v9, v57, v68
    v_dot2_f32_bf16 v69, v21, v57, v69
    v_dot2_f32_bf16 v70, v33, v57, v70
    v_dot2_f32_bf16 v71, v45, v57, v71
    v_dot2_f32_bf16 v68, v10, v58, v68
    v_dot2_f32_bf16 v69, v22, v58, v69
    v_dot2_f32_bf16 v70, v34, v58, v70
    v_dot2_f32_bf16 v71, v46, v58, v71
    v_dot2_f32_bf16 v68, v11, v59, v68
    v_dot2_f32_bf16 v69, v23, v59, v69
    v_dot2_f32_bf16 v70, v35, v59, v70
    v_dot2_f32_bf16 v71, v47, v59, v71
    v_dot2_f32_bf16 v68, v12, v60, v68
    v_dot2_f32_bf16 v69, v24, v60, v69
    v_dot2_f32_bf16 v70, v36, v60, v70
    v_dot2_f32_bf16 v71, v48, v60, v71
    v_dot2_f32_bf16 v68, v13, v61, v68
    v_dot2_f32_bf16 v69, v25, v61, v69
    v_dot2_f32_bf16 v70, v37, v61, v70
    v_dot2_f32_bf16 v71, v49, v61, v71
    v_dot2_f32_bf16 v68, v14, v62, v68
    v_dot2_f32_bf16 v69, v26, v62, v69
    v_dot2_f32_bf16 v70, v38, v62, v70
    v_dot2_f32_bf16 v71, v50, v62, v71
    v_dot2_f32_bf16 v68, v15, v63, v68
    v_dot2_f32_bf16 v69, v27, v63, v69
    v_dot2_f32_bf16 v70, v39, v63, v70
    v_dot2_f32_bf16 v71, v51, v63, v71
    v_dot2_f32_bf16 v68, v16, v64, v68
    v_dot2_f32_bf16 v69, v28, v64, v69
    v_dot2_f32_bf16 v70, v40, v64, v70
    v_dot2_f32_bf16 v71, v52, v64, v71
    v_dot2_f32_bf16 v68, v17, v65, v68
    v_dot2_f32_bf16 v69, v29, v65, v69
    v_dot2_f32_bf16 v70, v41, v65, v70
    v_dot2_f32_bf16 v71, v53, v65, v71
    v_dot2_f32_bf16 v68, v18, v66, v68
    v_dot2_f32_bf16 v69, v30, v66, v69
    v_dot2_f32_bf16 v70, v42, v66, v70
    v_dot2_f32_bf16 v71, v54, v66, v71
    v_dot2_f32_bf16 v68, v19, v67, v68
    v_dot2_f32_bf16 v69, v31, v67, v69
    v_dot2_f32_bf16 v70, v43, v67, v70
    v_dot2_f32_bf16 v71, v55, v67, v71
    v_add_f32_dpp v68, v68, v68 quad_perm:[1,0,3,2] row_mask:0xf bank_mask:0xf
    v_add_f32_dpp v69, v69, v69 quad_perm:[1,0,3,2] row_mask:0xf bank_mask:0xf
    v_add_f32_dpp v70, v70, v70 quad_perm:[1,0,3,2] row_mask:0xf bank_mask:0xf
    v_add_f32_dpp v71, v71, v71 quad_perm:[1,0,3,2] row_mask:0xf bank_mask:0xf
    v_add_f32_dpp v68, v68, v68 quad_perm:[2,3,0,1] row_mask:0xf bank_mask:0xf
    v_add_f32_dpp v69, v69, v69 quad_perm:[2,3,0,1] row_mask:0xf bank_mask:0xf
    v_add_f32_dpp v70, v70, v70 quad_perm:[2,3,0,1] row_mask:0xf bank_mask:0xf
    v_add_f32_dpp v71, v71, v71 quad_perm:[2,3,0,1] row_mask:0xf bank_mask:0xf
    v_add_f32_dpp v68, v68, v68 row_half_mirror row_mask:0xf bank_mask:0xf
    v_add_f32_dpp v69, v69, v69 row_half_mirror row_mask:0xf bank_mask:0xf
    v_add_f32_dpp v70, v70, v70 row_half_mirror row_mask:0xf bank_mask:0xf
    v_add_f32_dpp v71, v71, v71 row_half_mirror row_mask:0xf bank_mask:0xf
    v_cvt_pk_bf16_f32 v7, v68, v69
    v_lshlrev_b32 v68, 16, v7
    v_and_b32 v69, 0xffff0000, v7
    v_cvt_pk_bf16_f32 v7, v70, v71
    v_lshlrev_b32 v70, 16, v7
    v_and_b32 v71, 0xffff0000, v7
    v_mul_f32 v68, 0x3d93cd3a, v68
    v_mul_f32 v69, 0x3d93cd3a, v69
    v_mul_f32 v70, 0x3d93cd3a, v70
    v_mul_f32 v71, 0x3d93cd3a, v71
    v_cvt_pk_bf16_f32 v7, v68, v69
    v_lshlrev_b32 v68, 16, v7
    v_and_b32 v69, 0xffff0000, v7
    v_cvt_pk_bf16_f32 v7, v70, v71
    v_lshlrev_b32 v70, 16, v7
    v_and_b32 v71, 0xffff0000, v7
    v_max3_f32 v72, v68, v69, v70
    v_max_f32 v72, v72, v71
    s_nop 1
    v_max_f32_dpp v72, v72, v72 row_ror:8 row_mask:0xf bank_mask:0xf
    v_mov_b32 v74, v72
    s_nop 1
    v_permlane16_swap_b32 v74, v72
    v_max_f32 v72, v72, v74
    v_mov_b32 v74, v72
    s_nop 1
    v_permlane32_swap_b32 v74, v72
    v_max_f32 v72, v72, v74
    v_mul_f32 v72, s87, v72
    v_fma_f32 v68, v68, s87, -v72
    v_fma_f32 v69, v69, s87, -v72
    v_fma_f32 v70, v70, s87, -v72
    v_fma_f32 v71, v71, s87, -v72
    v_exp_f32 v68, v68
    v_exp_f32 v69, v69
    v_exp_f32 v70, v70
    v_exp_f32 v71, v71
    v_add_f32 v73, v68, v69
    v_add_f32 v75, v70, v71
    v_cndmask_b32 v68, v68, v69, s[88:89]
    v_add_f32 v73, v73, v75
    v_cndmask_b32 v68, v68, v70, s[90:91]
    v_cndmask_b32 v68, v68, v71, s[92:93]
    v_cvt_pk_bf16_f32 v68, v68, v68
    s_mov_b32 exec_lo, 0x0f0f0f0f
    s_mov_b32 exec_hi, 0x0f0f0f0f
    ds_write_b16 v4, v68
    s_mov_b64 exec, -1
    v_add_f32_dpp v73, v73, v73 row_ror:8 row_mask:0xf bank_mask:0xf
    v_mov_b32 v74, v73
    s_nop 1
    v_permlane16_swap_b32 v74, v73
    v_add_f32 v73, v73, v74
    v_mov_b32 v74, v73
    s_nop 1
    v_permlane32_swap_b32 v74, v73
    v_add_f32 v73, v73, v74
    s_mov_b64 exec, 1
    ds_write_b64 v5, v[72:73]
    s_mov_b64 exec, -1
    s_waitcnt lgkmcnt(0)
    v_mov_b32 v161, 1
    s_mov_b64 exec, 1
    ds_add_u32 v160, v161 offset:20
    s_mov_b64 exec, -1
    s_branch L_PV
L_VLOAD:
    s_mov_b32 s56, s12
    s_mov_b32 s57, s13
    s_mov_b32 s58, 100663296
    s_mov_b32 s59, 0x00020000
    s_mov_b32 s60, s16
    s_mov_b32 s61, s17
    s_mov_b32 s62, 7864320
    s_mov_b32 s63, 0x00020000
    v_add_u32 v60, 0, v0
    v_mul_u32_u24 v61, 2731, v60
    v_lshrrev_b32 v61, 16, v61
    v_mul_u32_u24 v62, 24, v61
    v_sub_u32 v62, v60, v62
    v_lshrrev_b32 v63, 1, v61
    v_and_b32 v63, 1, v63
    v_lshrrev_b32 v60, 1, v62
    v_xor_b32 v60, v60, v63
    v_lshlrev_b32 v60, 5, v60
    v_and_b32 v62, 1, v62
    v_lshlrev_b32 v62, 4, v62
    v_or_b32 v60, v60, v62
    v_mul_u32_u24 v62, 384, v61
    v_add_u32 v48, v62, v60
    v_xor_b32 v56, 64, v48
    v_add_u32 v60, 64, v0
    v_mul_u32_u24 v61, 2731, v60
    v_lshrrev_b32 v61, 16, v61
    v_mul_u32_u24 v62, 24, v61
    v_sub_u32 v62, v60, v62
    v_lshrrev_b32 v63, 1, v61
    v_and_b32 v63, 1, v63
    v_lshrrev_b32 v60, 1, v62
    v_xor_b32 v60, v60, v63
    v_lshlrev_b32 v60, 5, v60
    v_and_b32 v62, 1, v62
    v_lshlrev_b32 v62, 4, v62
    v_or_b32 v60, v60, v62
    v_mul_u32_u24 v62, 384, v61
    v_add_u32 v49, v62, v60
    v_xor_b32 v57, 64, v49
    v_add_u32 v60, 128, v0
    v_mul_u32_u24 v61, 2731, v60
    v_lshrrev_b32 v61, 16, v61
    v_mul_u32_u24 v62, 24, v61
    v_sub_u32 v62, v60, v62
    v_lshrrev_b32 v63, 1, v61
    v_and_b32 v63, 1, v63
    v_lshrrev_b32 v60, 1, v62
    v_xor_b32 v60, v60, v63
    v_lshlrev_b32 v60, 5, v60
    v_and_b32 v62, 1, v62
    v_lshlrev_b32 v62, 4, v62
    v_or_b32 v60, v60, v62
    v_mul_u32_u24 v62, 384, v61
    v_add_u32 v50, v62, v60
    v_xor_b32 v58, 64, v50
    v_lshrrev_b32 v60, 3, v0
    v_and_b32 v61, 7, v0
    v_lshrrev_b32 v62, 1, v60
    v_and_b32 v62, 1, v62
    v_lshrrev_b32 v63, 1, v61
    v_xor_b32 v63, v63, v62
    v_lshlrev_b32 v63, 5, v63
    v_and_b32 v62, 1, v61
    v_lshlrev_b32 v62, 4, v62
    v_or_b32 v63, v63, v62
    v_mul_u32_u24 v51, 1280, v60
    v_add_u32 v51, v51, v63
    v_xor_b32 v52, 64, v51
    s_mul_i32 s83, s82, 11
    s_and_b32 s6, s83, 1
    s_lshl_b32 s6, s6, 6
    v_xor_b32 v48, s6, v48
    v_xor_b32 v49, s6, v49
    v_xor_b32 v50, s6, v50
    v_xor_b32 v51, s6, v51
    s_mul_i32 s6, s83, 3072
    s_add_u32 s84, s6, s47
    s_add_u32 s85, s6, 0
    s_cmp_eq_u32 s82, 2
    s_cselect_b32 s86, 10, 11
    s_mov_b32 s89, s86
    s_mul_i32 s80, s4, 768
    s_lshl_b32 s6, s42, 8
    s_add_u32 s80, s80, s6
    s_lshl_b32 s6, s83, 3
    s_add_u32 s80, s80, s6
    s_mul_i32 s80, s80, 1280
    s_lshl_b32 s6, s43, 7
    s_add_u32 s80, s80, s6
    s_lshl_b32 s81, s83, 10
    s_add_u32 s81, s81, 98304
    s_mov_b32 s96, 0
SP_5:
    ds_read_b32 v161, v160 offset:52
    s_add_u32 s96, s96, 1
    s_waitcnt lgkmcnt(0)
    v_readfirstlane_b32 s97, v161
    s_nop 1
    s_cmp_ge_u32 s97, 8
    s_nop 0
    s_cbranch_scc1 SD_6
    s_cmp_gt_u32 s96, 1048576
    s_cbranch_scc1 SD_6
    s_sleep 1
    s_branch SP_5
SD_6:
L_VL_V:
    s_waitcnt vmcnt(8)
    s_mov_b32 m0, s85
    s_add_u32 s85, s85, 1024
    buffer_load_dwordx4 v48, s[56:59], s84 offen nt lds
    s_waitcnt vmcnt(8)
    s_mov_b32 m0, s85
    s_add_u32 s85, s85, 1024
    buffer_load_dwordx4 v49, s[56:59], s84 offen nt lds
    s_waitcnt vmcnt(8)
    s_mov_b32 m0, s85
    s_add_u32 s85, s85, 1024
    buffer_load_dwordx4 v50, s[56:59], s84 offen nt lds
    v_xor_b32 v48, 64, v48
    v_xor_b32 v49, 64, v49
    v_xor_b32 v50, 64, v50
    s_add_u32 s84, s84, 3072
    s_sub_u32 s86, s86, 1
    s_cmp_lg_u32 s86, 0
    s_cbranch_scc1 L_VL_V
    s_mov_b32 s79, 0
    s_cmp_ge_u32 s5, 30
    s_cbranch_scc1 L_PV
    s_mov_b32 s96, 0
SP_7:
    ds_read_b32 v161, v160 offset:36
    s_add_u32 s96, s96, 1
    s_waitcnt lgkmcnt(0)
    v_readfirstlane_b32 s97, v161
    s_nop 1
    s_cmp_ge_u32 s97, 3
    s_nop 0
    s_cbranch_scc1 SD_8
    s_cmp_gt_u32 s96, 1048576
    s_cbranch_scc1 SD_8
    s_sleep 1
    s_branch SP_7
SD_8:
    s_mov_b32 s79, s89
L_VL_W:
    s_mov_b32 m0, s81
    s_add_u32 s81, s81, 1024
    buffer_load_dwordx4 v51, s[60:63], s80 offen nt lds
    v_xor_b32 v51, 64, v51
    s_add_u32 s80, s80, 10240
    s_sub_u32 s89, s89, 1
    s_cmp_lg_u32 s89, 0
    s_cbranch_scc1 L_VL_W
    s_branch L_PV
L_CHAIN:
    s_mov_b32 s78, 4
    s_cmp_lt_u32 s5, 30
    s_cbranch_scc1 L_CH_ROLE
    s_mov_b32 s78, 10
L_CH_ROLE:
    s_setprio 3
    v_lshlrev_b32 v1, 2, v0
    v_mul_u32_u24 v2, 13, v0
    v_lshrrev_b32 v2, 8, v2
    v_mul_u32_u24 v3, 20, v2
    v_sub_u32 v3, v0, v3
    v_cmp_gt_u32 vcc, 40, v0
    v_mov_b32 v7, 0x80000000
    s_mul_i32 s6, s46, 160
    v_mul_u32_u24 v4, 1280, v2
    v_lshlrev_b32 v5, 3, v3
    v_add3_u32 v5, v4, v5, s6
    v_cndmask_b32 v5, v7, v5, vcc
    s_and_b32 s6, s4, 3
    s_mul_i32 s6, s6, 320
    v_lshlrev_b32 v6, 4, v3
    v_add3_u32 v6, v4, v6, s6
    v_cndmask_b32 v6, v7, v6, vcc
    s_waitcnt lgkmcnt(0)
    s_barrier
    s_mov_b32 s36, s34
    s_mov_b32 s37, s35
    s_mov_b32 s38, 2097280
    s_mov_b32 s39, 0x00020000
    s_mov_b32 s56, s8
    s_mov_b32 s57, s9
    s_mov_b32 s58, 2560
    s_mov_b32 s59, 0x00020000
    s_mov_b32 s60, s26
    s_mov_b32 s61, s27
    s_mov_b32 s62, 2560
    s_mov_b32 s63, 0x00020000
    buffer_load_dwordx4 v[20:23], v6, s[60:63], 0 offen
    buffer_load_dword v8, v1, s[56:59], 0 offen offset:0
    buffer_load_dword v9, v1, s[56:59], 0 offen offset:256
    buffer_load_dword v10, v1, s[56:59], 0 offen offset:512
    buffer_load_dword v11, v1, s[56:59], 0 offen offset:768
    buffer_load_dword v12, v1, s[56:59], 0 offen offset:1024
    buffer_load_dword v13, v1, s[56:59], 0 offen offset:1280
    buffer_load_dword v14, v1, s[56:59], 0 offen offset:1536
    buffer_load_dword v15, v1, s[56:59], 0 offen offset:1792
    buffer_load_dword v16, v1, s[56:59], 0 offen offset:2048
    buffer_load_dword v17, v1, s[56:59], 0 offen offset:2304
    buffer_load_dwordx2 v[18:19], v5, s[56:59], 0 offen
    s_waitcnt vmcnt(11)
    v_lshlrev_b32 v24, 16, v20
    v_and_b32 v25, 0xffff0000, v20
    v_lshlrev_b32 v26, 16, v21
    v_and_b32 v27, 0xffff0000, v21
    v_lshlrev_b32 v28, 16, v22
    v_and_b32 v29, 0xffff0000, v22
    v_lshlrev_b32 v30, 16, v23
    v_and_b32 v31, 0xffff0000, v23
    v_mul_f32 v32, 0xbfb8aa3b, v24
    v_mul_f32 v33, 0xbfb8aa3b, v25
    v_mul_f32 v34, 0xbfb8aa3b, v26
    v_mul_f32 v35, 0xbfb8aa3b, v27
    v_mul_f32 v36, 0xbfb8aa3b, v28
    v_mul_f32 v37, 0xbfb8aa3b, v29
    v_mul_f32 v38, 0xbfb8aa3b, v30
    v_mul_f32 v39, 0xbfb8aa3b, v31
    v_exp_f32 v32, v32
    v_exp_f32 v33, v33
    v_exp_f32 v34, v34
    v_exp_f32 v35, v35
    v_exp_f32 v36, v36
    v_exp_f32 v37, v37
    v_exp_f32 v38, v38
    v_exp_f32 v39, v39
    v_add_f32 v32, 1.0, v32
    v_add_f32 v33, 1.0, v33
    v_add_f32 v34, 1.0, v34
    v_add_f32 v35, 1.0, v35
    v_add_f32 v36, 1.0, v36
    v_add_f32 v37, 1.0, v37
    v_add_f32 v38, 1.0, v38
    v_add_f32 v39, 1.0, v39
    v_rcp_f32 v40, v32
    v_rcp_f32 v41, v33
    v_rcp_f32 v42, v34
    v_rcp_f32 v43, v35
    v_rcp_f32 v44, v36
    v_rcp_f32 v45, v37
    v_rcp_f32 v46, v38
    v_rcp_f32 v47, v39
    v_mul_f32 v48, v24, v40
    v_fma_f32 v56, -v48, v32, v24
    v_fma_f32 v48, v56, v40, v48
    v_mul_f32 v49, v25, v41
    v_fma_f32 v56, -v49, v33, v25
    v_fma_f32 v49, v56, v41, v49
    v_mul_f32 v50, v26, v42
    v_fma_f32 v56, -v50, v34, v26
    v_fma_f32 v50, v56, v42, v50
    v_mul_f32 v51, v27, v43
    v_fma_f32 v56, -v51, v35, v27
    v_fma_f32 v51, v56, v43, v51
    v_mul_f32 v52, v28, v44
    v_fma_f32 v56, -v52, v36, v28
    v_fma_f32 v52, v56, v44, v52
    v_mul_f32 v53, v29, v45
    v_fma_f32 v56, -v53, v37, v29
    v_fma_f32 v53, v56, v45, v53
    v_mul_f32 v54, v30, v46
    v_fma_f32 v56, -v54, v38, v30
    v_fma_f32 v54, v56, v46, v54
    v_mul_f32 v55, v31, v47
    v_fma_f32 v56, -v55, v39, v31
    v_fma_f32 v55, v56, v47, v55
    v_cvt_pk_bf16_f32 v20, v48, v49
    v_cvt_pk_bf16_f32 v21, v50, v51
    v_cvt_pk_bf16_f32 v22, v52, v53
    v_cvt_pk_bf16_f32 v23, v54, v55
    v_mul_u32_u24 v4, 320, v2
    v_lshlrev_b32 v7, 4, v3
    v_add_u32 v4, v4, v7
    v_add_u32 v4, 131072, v4
    s_mov_b32 exec_hi, 0xff
    ds_write_b128 v4, v[20:23]
    s_mov_b32 exec_hi, -1
    s_waitcnt lgkmcnt(0)
    v_mov_b32 v161, 1
    ds_write_b32 v160, v161 offset:12
    s_mov_b32 s96, 0
SP_9:
    ds_read_b32 v161, v160 offset:24
    s_add_u32 s96, s96, 1
    s_waitcnt lgkmcnt(0)
    v_readfirstlane_b32 s97, v161
    s_nop 1
    s_cmp_ge_u32 s97, 256
    s_nop 0
    s_cbranch_scc1 SD_10
    s_cmp_gt_u32 s96, 1048576
    s_cbranch_scc1 SD_10
    s_sleep 1
    s_branch SP_9
SD_10:
    s_and_b32 s95, s97, 0xff
    v_mov_b32 v163, s95
    s_waitcnt vmcnt(0)
    s_branch L_CH_LN
L_MSTAGE:
    v_lshrrev_b32 v100, 4, v0
    v_lshrrev_b32 v101, 2, v0
    v_and_b32 v101, 3, v101
    v_and_b32 v102, 3, v0
    v_lshrrev_b32 v103, 1, v101
    v_and_b32 v104, 1, v100
    v_lshlrev_b32 v104, 1, v104
    v_or_b32 v103, v103, v104
    v_lshlrev_b32 v104, 3, v100
    v_add_u32 v104, v104, v101
    v_lshlrev_b32 v105, 3, v102
    s_sub_u32 s72, s3, 10
    s_lshl_b32 s73, s72, 1
    v_xor_b32 v106, s73, v103
    v_lshlrev_b32 v106, 5, v106
    v_lshlrev_b32 v107, 7, v104
    v_add_u32 v107, v107, v105
    v_add_u32 v107, 135680, v107
    v_xor_b32 v112, 32, v106
    v_add_u32 v112, v112, v107
    v_add_u32 v107, v106, v107
    v_and_b32 v108, 1, v0
    v_mul_u32_u24 v108, 320, v108
    v_lshlrev_b32 v109, 4, v100
    v_add_u32 v108, v108, v109
    v_add_u32 v108, 131072, v108
    v_lshrrev_b32 v110, 1, v100
    v_lshlrev_b32 v110, 8, v110
    v_and_b32 v111, 1, v100
    v_lshlrev_b32 v111, 6, v111
    v_and_b32 v113, 15, v0
    v_lshlrev_b32 v113, 2, v113
    v_add3_u32 v110, v110, v111, v113
    s_lshl_b32 s6, s72, 7
    v_add_u32 v110, s6, v110
    s_mov_b32 s96, 0
    s_nop 0
SP_11:
    ds_read_b32 v161, v160 offset:12
    s_add_u32 s96, s96, 1
    s_waitcnt lgkmcnt(0)
    v_readfirstlane_b32 s97, v161
    s_nop 1
    s_cmp_ge_u32 s97, 1
    s_nop 0
    s_cbranch_scc1 SD_12
    s_cmp_gt_u32 s96, 1048576
    s_cbranch_scc1 SD_12
    s_sleep 1
    s_branch SP_11
SD_12:
    ds_read_b128 v[48:51], v108 offset:0
    ds_read_b128 v[52:55], v108 offset:64
    ds_read_b128 v[56:59], v108 offset:128
    ds_read_b128 v[60:63], v108 offset:192
    ds_read_b128 v[64:67], v108 offset:256
    s_mov_b32 s96, 0
SP_13:
    ds_read_b32 v161, v160 offset:4
    s_add_u32 s96, s96, 1
    s_waitcnt lgkmcnt(0)
    v_readfirstlane_b32 s97, v161
    s_nop 1
    s_cmp_ge_u32 s97, 1
    s_nop 0
    s_cbranch_scc1 SD_14
    s_cmp_gt_u32 s96, 1048576
    s_cbranch_scc1 SD_14
    s_sleep 1
    s_branch SP_13
SD_14:
    ds_read_b64_tr_b16 v[68:69], v107 offset:0
    ds_read_b64_tr_b16 v[70:71], v107 offset:512
    ds_read_b64_tr_b16 v[72:73], v107 offset:4096
    ds_read_b64_tr_b16 v[74:75], v107 offset:4608
    ds_read_b64_tr_b16 v[76:77], v107 offset:8192
    ds_read_b64_tr_b16 v[78:79], v107 offset:8704
    ds_read_b64_tr_b16 v[80:81], v107 offset:12288
    ds_read_b64_tr_b16 v[82:83], v107 offset:12800
    ds_read_b64_tr_b16 v[84:85], v107 offset:16384
    ds_read_b64_tr_b16 v[86:87], v107 offset:16896
    s_waitcnt lgkmcnt(8)
    v_mfma_f32_16x16x32_bf16 v[96:99], v[48:51], v[68:71], 0
    ds_read_b64_tr_b16 v[120:121], v112 offset:0
    ds_read_b64_tr_b16 v[122:123], v112 offset:512
    s_waitcnt lgkmcnt(8)
    v_mfma_f32_16x16x32_bf16 v[96:99], v[52:55], v[72:75], v[96:99]
    ds_read_b64_tr_b16 v[124:125], v112 offset:4096
    ds_read_b64_tr_b16 v[126:127], v112 offset:4608
    s_waitcnt lgkmcnt(8)
    v_mfma_f32_16x16x32_bf16 v[96:99], v[56:59], v[76:79], v[96:99]
    ds_read_b64_tr_b16 v[128:129], v112 offset:8192
    ds_read_b64_tr_b16 v[130:131], v112 offset:8704
    s_waitcnt lgkmcnt(8)
    v_mfma_f32_16x16x32_bf16 v[96:99], v[60:63], v[80:83], v[96:99]
    ds_read_b64_tr_b16 v[132:133], v112 offset:12288
    ds_read_b64_tr_b16 v[134:135], v112 offset:12800
    s_waitcnt lgkmcnt(8)
    v_mfma_f32_16x16x32_bf16 v[96:99], v[64:67], v[84:87], v[96:99]
    ds_read_b64_tr_b16 v[136:137], v112 offset:16384
    ds_read_b64_tr_b16 v[138:139], v112 offset:16896
    s_waitcnt lgkmcnt(8)
    v_mfma_f32_16x16x32_bf16 v[140:143], v[48:51], v[120:123], 0
    s_waitcnt lgkmcnt(6)
    v_mfma_f32_16x16x32_bf16 v[140:143], v[52:55], v[124:127], v[140:143]
    s_waitcnt lgkmcnt(4)
    v_mfma_f32_16x16x32_bf16 v[140:143], v[56:59], v[128:131], v[140:143]
    s_waitcnt lgkmcnt(2)
    v_mfma_f32_16x16x32_bf16 v[140:143], v[60:63], v[132:135], v[140:143]
    s_waitcnt lgkmcnt(0)
    v_mfma_f32_16x16x32_bf16 v[140:143], v[64:67], v[136:139], v[140:143]
    s_nop 7
    v_cndmask_b32 v96, v96, v140, s[48:49]
    v_cndmask_b32 v96, v96, v97, s[50:51]
    v_cndmask_b32 v96, v96, v141, s[52:53]
    v_bfi_b32 v96, v162, v163, v96
    buffer_store_dword v96, v110, s[36:39], s44 offen offset:0 sc1
    s_branch L_POST_M
L_CH_LN:
    v_lshlrev_b32 v24, 16, v8
    v_and_b32 v25, 0xffff0000, v8
    v_lshlrev_b32 v26, 16, v9
    v_and_b32 v27, 0xffff0000, v9
    v_lshlrev_b32 v28, 16, v10
    v_and_b32 v29, 0xffff0000, v10
    v_lshlrev_b32 v30, 16, v11
    v_and_b32 v31, 0xffff0000, v11
    v_lshlrev_b32 v32, 16, v12
    v_and_b32 v33, 0xffff0000, v12
    v_lshlrev_b32 v34, 16, v13
    v_and_b32 v35, 0xffff0000, v13
    v_lshlrev_b32 v36, 16, v14
    v_and_b32 v37, 0xffff0000, v14
    v_lshlrev_b32 v38, 16, v15
    v_and_b32 v39, 0xffff0000, v15
    v_lshlrev_b32 v40, 16, v16
    v_and_b32 v41, 0xffff0000, v16
    v_lshlrev_b32 v42, 16, v17
    v_and_b32 v43, 0xffff0000, v17
    v_add_f32 v44, v24, v25
    v_add_f32 v44, v44, v26
    v_add_f32 v44, v44, v27
    v_add_f32 v44, v44, v28
    v_add_f32 v44, v44, v29
    v_add_f32 v44, v44, v30
    v_add_f32 v44, v44, v31
    v_add_f32 v44, v44, v32
    v_add_f32 v44, v44, v33
    v_add_f32 v45, v34, v35
    v_add_f32 v45, v45, v36
    v_add_f32 v45, v45, v37
    v_add_f32 v45, v45, v38
    v_add_f32 v45, v45, v39
    v_add_f32 v45, v45, v40
    v_add_f32 v45, v45, v41
    v_add_f32 v45, v45, v42
    v_add_f32 v45, v45, v43
    v_add_f32_dpp v44, v44, v44 row_ror:8 row_mask:0xf bank_mask:0xf
    s_nop 0
    v_add_f32_dpp v45, v45, v45 row_ror:8 row_mask:0xf bank_mask:0xf
    v_add_f32_dpp v44, v44, v44 row_ror:4 row_mask:0xf bank_mask:0xf
    s_nop 0
    v_add_f32_dpp v45, v45, v45 row_ror:4 row_mask:0xf bank_mask:0xf
    v_add_f32_dpp v44, v44, v44 row_ror:2 row_mask:0xf bank_mask:0xf
    s_nop 0
    v_add_f32_dpp v45, v45, v45 row_ror:2 row_mask:0xf bank_mask:0xf
    v_add_f32_dpp v44, v44, v44 row_ror:1 row_mask:0xf bank_mask:0xf
    s_nop 0
    v_add_f32_dpp v45, v45, v45 row_ror:1 row_mask:0xf bank_mask:0xf
    v_mov_b32 v50, v44
    v_mov_b32 v51, v45
    s_nop 0
    v_permlane16_swap_b32 v50, v44
    v_permlane16_swap_b32 v51, v45
    v_add_f32 v44, v44, v50
    v_add_f32 v45, v45, v51
    v_mov_b32 v50, v44
    v_mov_b32 v51, v45
    s_nop 0
    v_permlane32_swap_b32 v50, v44
    v_permlane32_swap_b32 v51, v45
    v_add_f32 v44, v44, v50
    v_add_f32 v45, v45, v51
    v_mul_f32 v44, 0x3acccccd, v44
    v_mul_f32 v45, 0x3acccccd, v45
    v_sub_f32 v24, v24, v44
    v_sub_f32 v25, v25, v44
    v_sub_f32 v26, v26, v44
    v_sub_f32 v27, v27, v44
    v_sub_f32 v28, v28, v44
    v_sub_f32 v29, v29, v44
    v_sub_f32 v30, v30, v44
    v_sub_f32 v31, v31, v44
    v_sub_f32 v32, v32, v44
    v_sub_f32 v33, v33, v44
    v_mul_f32 v46, v24, v24
    v_fma_f32 v46, v25, v25, v46
    v_fma_f32 v46, v26, v26, v46
    v_fma_f32 v46, v27, v27, v46
    v_fma_f32 v46, v28, v28, v46
    v_fma_f32 v46, v29, v29, v46
    v_fma_f32 v46, v30, v30, v46
    v_fma_f32 v46, v31, v31, v46
    v_fma_f32 v46, v32, v32, v46
    v_fma_f32 v46, v33, v33, v46
    v_sub_f32 v34, v34, v45
    v_sub_f32 v35, v35, v45
    v_sub_f32 v36, v36, v45
    v_sub_f32 v37, v37, v45
    v_sub_f32 v38, v38, v45
    v_sub_f32 v39, v39, v45
    v_sub_f32 v40, v40, v45
    v_sub_f32 v41, v41, v45
    v_sub_f32 v42, v42, v45
    v_sub_f32 v43, v43, v45
    v_mul_f32 v47, v34, v34
    v_fma_f32 v47, v35, v35, v47
    v_fma_f32 v47, v36, v36, v47
    v_fma_f32 v47, v37, v37, v47
    v_fma_f32 v47, v38, v38, v47
    v_fma_f32 v47, v39, v39, v47
    v_fma_f32 v47, v40, v40, v47
    v_fma_f32 v47, v41, v41, v47
    v_fma_f32 v47, v42, v42, v47
    v_fma_f32 v47, v43, v43, v47
    v_add_f32_dpp v46, v46, v46 row_ror:8 row_mask:0xf bank_mask:0xf
    s_nop 0
    v_add_f32_dpp v47, v47, v47 row_ror:8 row_mask:0xf bank_mask:0xf
    v_add_f32_dpp v46, v46, v46 row_ror:4 row_mask:0xf bank_mask:0xf
    s_nop 0
    v_add_f32_dpp v47, v47, v47 row_ror:4 row_mask:0xf bank_mask:0xf
    v_add_f32_dpp v46, v46, v46 row_ror:2 row_mask:0xf bank_mask:0xf
    s_nop 0
    v_add_f32_dpp v47, v47, v47 row_ror:2 row_mask:0xf bank_mask:0xf
    v_add_f32_dpp v46, v46, v46 row_ror:1 row_mask:0xf bank_mask:0xf
    s_nop 0
    v_add_f32_dpp v47, v47, v47 row_ror:1 row_mask:0xf bank_mask:0xf
    v_mov_b32 v50, v46
    v_mov_b32 v51, v47
    s_nop 0
    v_permlane16_swap_b32 v50, v46
    v_permlane16_swap_b32 v51, v47
    v_add_f32 v46, v46, v50
    v_add_f32 v47, v47, v51
    v_mov_b32 v50, v46
    v_mov_b32 v51, v47
    s_nop 0
    v_permlane32_swap_b32 v50, v46
    v_permlane32_swap_b32 v51, v47
    v_add_f32 v46, v46, v50
    v_add_f32 v47, v47, v51
    v_mul_f32 v46, 0x3acccccd, v46
    v_mul_f32 v47, 0x3acccccd, v47
    v_cvt_pk_bf16_f32 v50, v44, v46
    v_lshlrev_b32 v44, 16, v50
    v_and_b32 v46, 0xffff0000, v50
    v_add_f32 v46, 0x3727c5ac, v46
    v_cvt_pk_bf16_f32 v46, v46, v46
    v_lshlrev_b32 v46, 16, v46
    v_sqrt_f32 v46, v46
    s_nop 0
    v_cvt_pk_bf16_f32 v46, v46, v46
    v_lshlrev_b32 v46, 16, v46
    v_cvt_pk_bf16_f32 v50, v45, v47
    v_lshlrev_b32 v45, 16, v50
    v_and_b32 v47, 0xffff0000, v50
    v_add_f32 v47, 0x3727c5ac, v47
    v_cvt_pk_bf16_f32 v47, v47, v47
    v_lshlrev_b32 v47, 16, v47
    v_sqrt_f32 v47, v47
    s_nop 0
    v_cvt_pk_bf16_f32 v47, v47, v47
    v_lshlrev_b32 v47, 16, v47
    v_cmp_eq_u32 vcc, 1, v2
    s_nop 1
    v_cndmask_b32 v44, v44, v45, vcc
    v_cndmask_b32 v46, v46, v47, vcc
    v_rcp_f32 v47, v46
    v_lshlrev_b32 v24, 16, v18
    v_and_b32 v25, 0xffff0000, v18
    v_lshlrev_b32 v26, 16, v19
    v_and_b32 v27, 0xffff0000, v19
    v_sub_f32 v24, v24, v44
    v_sub_f32 v25, v25, v44
    v_sub_f32 v26, v26, v44
    v_sub_f32 v27, v27, v44
    v_cvt_pk_bf16_f32 v50, v24, v25
    v_lshlrev_b32 v24, 16, v50
    v_and_b32 v25, 0xffff0000, v50
    v_cvt_pk_bf16_f32 v50, v26, v27
    v_lshlrev_b32 v26, 16, v50
    v_and_b32 v27, 0xffff0000, v50
    v_mul_f32 v28, v24, v47
    v_fma_f32 v50, -v28, v46, v24
    v_fma_f32 v28, v50, v47, v28
    v_mul_f32 v29, v25, v47
    v_fma_f32 v50, -v29, v46, v25
    v_fma_f32 v29, v50, v47, v29
    v_mul_f32 v30, v26, v47
    v_fma_f32 v50, -v30, v46, v26
    v_fma_f32 v30, v50, v47, v30
    v_mul_f32 v31, v27, v47
    v_fma_f32 v50, -v31, v46, v27
    v_fma_f32 v31, v50, v47, v31
    v_cvt_pk_bf16_f32 v50, v28, v29
    v_lshlrev_b32 v28, 16, v50
    v_and_b32 v29, 0xffff0000, v50
    v_cvt_pk_bf16_f32 v50, v30, v31
    v_lshlrev_b32 v30, 16, v50
    v_and_b32 v31, 0xffff0000, v50
    s_mov_b32 s68, -1
    s_mov_b32 s69, 0xff
    s_mov_b32 s70, -1
    s_mov_b32 s71, 0xffff
    s_mul_i32 s6, s46, 80
    v_lshlrev_b32 v4, 2, v3
    v_add_u32 v4, s6, v4
    v_lshlrev_b32 v5, 8, v2
    v_mov_b32 v7, 0x80000000
    v_cmp_gt_u32 vcc, 40, v0
    v_add_u32 v6, 0, v4
    v_lshrrev_b32 v15, 6, v6
    v_lshlrev_b32 v15, 16, v15
    v_and_b32 v6, 63, v6
    v_lshlrev_b32 v6, 2, v6
    v_add3_u32 v6, v6, v15, v5
    v_cndmask_b32 v20, v7, v6, vcc
    v_add_u32 v6, 640, v4
    v_lshrrev_b32 v15, 6, v6
    v_lshlrev_b32 v15, 16, v15
    v_and_b32 v6, 63, v6
    v_lshlrev_b32 v6, 2, v6
    v_add3_u32 v6, v6, v15, v5
    v_cndmask_b32 v21, v7, v6, vcc
    s_mov_b32 s84, 0
    s_mov_b32 s85, 8192
    s_mov_b32 s86, 16384
    s_mov_b32 s87, 24576
    v_lshrrev_b32 v100, 4, v0
    v_lshrrev_b32 v101, 2, v0
    v_and_b32 v101, 3, v101
    v_and_b32 v102, 3, v0
    v_lshrrev_b32 v103, 1, v101
    v_and_b32 v104, 1, v100
    v_lshlrev_b32 v104, 1, v104
    v_or_b32 v103, v103, v104
    v_lshlrev_b32 v104, 3, v100
    v_add_u32 v104, v104, v101
    v_lshlrev_b32 v105, 3, v102
    v_mul_u32_u24 v106, 384, v104
    v_add_u32 v106, v106, v105
    v_add_u32 v106, 98304, v106
    v_lshlrev_b32 v107, 2, v100
    v_add_u32 v107, v107, v101
    v_mul_u32_u24 v107, 384, v107
    v_add_u32 v107, v107, v105
    v_add_u32 v107, 122880, v107
    v_lshrrev_b32 v108, 1, v101
    v_and_b32 v109, 2, v100
    v_or_b32 v108, v108, v109
    v_and_b32 v6, 1, v0
    v_mul_u32_u24 v6, 160, v6
    v_add_u32 v6, 131712, v6
    v_lshlrev_b32 v94, 4, v100
    v_add_u32 v94, v94, v6
    v_lshlrev_b32 v95, 3, v100
    v_add_u32 v95, v95, v6
    v_xor_b32 v156, 0, v103
    v_lshlrev_b32 v156, 5, v156
    v_add_u32 v156, v156, v106
    v_xor_b32 v96, 0, v108
    v_lshlrev_b32 v96, 5, v96
    v_add_u32 v96, v96, v107
    v_xor_b32 v157, 1, v103
    v_lshlrev_b32 v157, 5, v157
    v_add_u32 v157, v157, v106
    v_xor_b32 v97, 1, v108
    v_lshlrev_b32 v97, 5, v97
    v_add_u32 v97, v97, v107
    v_xor_b32 v158, 2, v103
    v_lshlrev_b32 v158, 5, v158
    v_add_u32 v158, v158, v106
    v_xor_b32 v98, 2, v108
    v_lshlrev_b32 v98, 5, v98
    v_add_u32 v98, v98, v107
    v_xor_b32 v159, 3, v103
    v_lshlrev_b32 v159, 5, v159
    v_add_u32 v159, v159, v106
    v_xor_b32 v99, 3, v108
    v_lshlrev_b32 v99, 5, v99
    v_add_u32 v99, v99, v107
    s_mov_b32 s96, 0
    s_nop 0
SP_15:
    ds_read_b32 v161, v160 offset:8
    s_add_u32 s96, s96, 1
    s_waitcnt lgkmcnt(0)
    v_readfirstlane_b32 s97, v161
    s_nop 1
    s_cmp_ge_u32 s97, 1
    s_nop 0
    s_cbranch_scc1 SD_16
    s_cmp_gt_u32 s96, 1048576
    s_cbranch_scc1 SD_16
    s_sleep 1
    s_branch SP_15
SD_16:
    ds_read_b64_tr_b16 v[64:65], v156 offset:0
    ds_read_b64_tr_b16 v[66:67], v156 offset:1536
    ds_read_b64_tr_b16 v[68:69], v156 offset:12288
    ds_read_b64_tr_b16 v[70:71], v156 offset:13824
    ds_read_b64_tr_b16 v[72:73], v96 offset:0
    ds_read_b64_tr_b16 v[74:75], v157 offset:0
    ds_read_b64_tr_b16 v[76:77], v157 offset:1536
    ds_read_b64_tr_b16 v[78:79], v157 offset:12288
    ds_read_b64_tr_b16 v[80:81], v157 offset:13824
    ds_read_b64_tr_b16 v[82:83], v97 offset:0
    s_waitcnt lgkmcnt(5)
    ds_read_b64_tr_b16 v[84:85], v158 offset:0
    ds_read_b64_tr_b16 v[86:87], v158 offset:1536
    ds_read_b64_tr_b16 v[88:89], v158 offset:12288
    ds_read_b64_tr_b16 v[90:91], v158 offset:13824
    ds_read_b64_tr_b16 v[92:93], v98 offset:0
    ds_read_b64_tr_b16 v[116:117], v159 offset:0
    ds_read_b64_tr_b16 v[118:119], v159 offset:1536
    ds_read_b64_tr_b16 v[120:121], v159 offset:12288
    ds_read_b64_tr_b16 v[122:123], v159 offset:13824
    ds_read_b64_tr_b16 v[124:125], v99 offset:0
    s_waitcnt lgkmcnt(5)
    ds_read_b64_tr_b16 v[126:127], v156 offset:128
    ds_read_b64_tr_b16 v[128:129], v156 offset:1664
    ds_read_b64_tr_b16 v[130:131], v156 offset:12416
    ds_read_b64_tr_b16 v[132:133], v156 offset:13952
    ds_read_b64_tr_b16 v[134:135], v96 offset:128
    ds_read_b64_tr_b16 v[136:137], v157 offset:128
    ds_read_b64_tr_b16 v[138:139], v157 offset:1664
    ds_read_b64_tr_b16 v[140:141], v157 offset:12416
    ds_read_b64_tr_b16 v[142:143], v157 offset:13952
    ds_read_b64_tr_b16 v[144:145], v97 offset:128
    s_waitcnt lgkmcnt(5)
    ds_read_b64_tr_b16 v[146:147], v158 offset:128
    ds_read_b64_tr_b16 v[148:149], v158 offset:1664
    ds_read_b64_tr_b16 v[150:151], v158 offset:12416
    ds_read_b64_tr_b16 v[152:153], v158 offset:13952
    ds_read_b64_tr_b16 v[154:155], v98 offset:128
    buffer_load_dwordx4 v[32:35], v20, s[36:39], s84 offen offset:0 sc1
    buffer_load_dwordx4 v[36:39], v20, s[36:39], s85 offen offset:0 sc1
    buffer_load_dwordx4 v[40:43], v20, s[36:39], s86 offen offset:0 sc1
    buffer_load_dwordx4 v[44:47], v20, s[36:39], s87 offen offset:0 sc1
    buffer_load_dwordx4 v[48:51], v21, s[36:39], s84 offen offset:0 sc1
    buffer_load_dwordx4 v[52:55], v21, s[36:39], s85 offen offset:0 sc1
    buffer_load_dwordx4 v[56:59], v21, s[36:39], s86 offen offset:0 sc1
    buffer_load_dwordx4 v[60:63], v21, s[36:39], s87 offen offset:0 sc1
    s_mov_b32 s96, 0
SL_17:
    s_add_u32 s96, s96, 1
    s_waitcnt vmcnt(0)
    v_cmp_ne_u32_sdwa s[64:65], v35, s95 src0_sel:BYTE_0 src1_sel:BYTE_0
    v_cmp_ne_u32_sdwa s[66:67], v39, s95 src0_sel:BYTE_0 src1_sel:BYTE_0
    v_cmp_ne_u32_sdwa s[72:73], v43, s95 src0_sel:BYTE_0 src1_sel:BYTE_0
    v_cmp_ne_u32_sdwa s[76:77], v47, s95 src0_sel:BYTE_0 src1_sel:BYTE_0
    v_cmp_ne_u32_sdwa s[80:81], v51, s95 src0_sel:BYTE_0 src1_sel:BYTE_0
    v_cmp_ne_u32_sdwa s[82:83], v55, s95 src0_sel:BYTE_0 src1_sel:BYTE_0
    v_cmp_ne_u32_sdwa s[90:91], v59, s95 src0_sel:BYTE_0 src1_sel:BYTE_0
    v_cmp_ne_u32_sdwa s[92:93], v63, s95 src0_sel:BYTE_0 src1_sel:BYTE_0
    s_and_b64 s[64:65], s[64:65], s[68:69]
    s_and_b64 s[66:67], s[66:67], s[68:69]
    s_and_b64 s[72:73], s[72:73], s[68:69]
    s_and_b64 s[76:77], s[76:77], s[68:69]
    s_and_b64 s[80:81], s[80:81], s[68:69]
    s_and_b64 s[82:83], s[82:83], s[68:69]
    s_and_b64 s[90:91], s[90:91], s[68:69]
    s_and_b64 s[92:93], s[92:93], s[68:69]
    s_or_b64 vcc, s[64:65], s[66:67]
    s_or_b64 vcc, vcc, s[72:73]
    s_or_b64 vcc, vcc, s[76:77]
    s_or_b64 vcc, vcc, s[80:81]
    s_or_b64 vcc, vcc, s[82:83]
    s_or_b64 vcc, vcc, s[90:91]
    s_or_b64 vcc, vcc, s[92:93]
    s_cbranch_scc0 SE_18
    s_cmp_gt_u32 s96, 32768
    s_cbranch_scc1 SE_18
    s_cmp_lg_u64 s[64:65], 0
    s_cbranch_scc0 SK_19
    buffer_load_dwordx4 v[32:35], v20, s[36:39], s84 offen offset:0 sc1
SK_19:
    s_cmp_lg_u64 s[66:67], 0
    s_cbranch_scc0 SK_20
    buffer_load_dwordx4 v[36:39], v20, s[36:39], s85 offen offset:0 sc1
SK_20:
    s_cmp_lg_u64 s[72:73], 0
    s_cbranch_scc0 SK_21
    buffer_load_dwordx4 v[40:43], v20, s[36:39], s86 offen offset:0 sc1
SK_21:
    s_cmp_lg_u64 s[76:77], 0
    s_cbranch_scc0 SK_22
    buffer_load_dwordx4 v[44:47], v20, s[36:39], s87 offen offset:0 sc1
SK_22:
    s_cmp_lg_u64 s[80:81], 0
    s_cbranch_scc0 SK_23
    buffer_load_dwordx4 v[48:51], v21, s[36:39], s84 offen offset:0 sc1
SK_23:
    s_cmp_lg_u64 s[82:83], 0
    s_cbranch_scc0 SK_24
    buffer_load_dwordx4 v[52:55], v21, s[36:39], s85 offen offset:0 sc1
SK_24:
    s_cmp_lg_u64 s[90:91], 0
    s_cbranch_scc0 SK_25
    buffer_load_dwordx4 v[56:59], v21, s[36:39], s86 offen offset:0 sc1
SK_25:
    s_cmp_lg_u64 s[92:93], 0
    s_cbranch_scc0 SK_26
    buffer_load_dwordx4 v[60:63], v21, s[36:39], s87 offen offset:0 sc1
SK_26:
    s_branch SL_17
SE_18:
    v_and_b32 v35, 0xffffff00, v35
    v_and_b32 v39, 0xffffff00, v39
    v_and_b32 v43, 0xffffff00, v43
    v_and_b32 v47, 0xffffff00, v47
    v_and_b32 v51, 0xffffff00, v51
    v_and_b32 v55, 0xffffff00, v55
    v_and_b32 v59, 0xffffff00, v59
    v_and_b32 v63, 0xffffff00, v63
    v_pk_add_f32 v[100:101], v[32:33], v[36:37]
    v_pk_add_f32 v[104:105], v[40:41], v[44:45]
    v_pk_add_f32 v[102:103], v[34:35], v[38:39]
    v_pk_add_f32 v[106:107], v[42:43], v[46:47]
    v_pk_add_f32 v[100:101], v[100:101], v[104:105]
    v_pk_add_f32 v[102:103], v[102:103], v[106:107]
    v_pk_add_f32 v[108:109], v[48:49], v[52:53]
    v_pk_add_f32 v[112:113], v[56:57], v[60:61]
    v_pk_add_f32 v[110:111], v[50:51], v[54:55]
    v_pk_add_f32 v[114:115], v[58:59], v[62:63]
    v_pk_add_f32 v[108:109], v[108:109], v[112:113]
    v_pk_add_f32 v[110:111], v[110:111], v[114:115]
    v_cvt_pk_bf16_f32 v22, v100, v101
    v_lshlrev_b32 v100, 16, v22
    v_and_b32 v101, 0xffff0000, v22
    v_cvt_pk_bf16_f32 v22, v102, v103
    v_lshlrev_b32 v102, 16, v22
    v_and_b32 v103, 0xffff0000, v22
    v_cvt_pk_bf16_f32 v22, v108, v109
    v_lshlrev_b32 v108, 16, v22
    v_and_b32 v109, 0xffff0000, v22
    v_cvt_pk_bf16_f32 v22, v110, v111
    v_lshlrev_b32 v110, 16, v22
    v_and_b32 v111, 0xffff0000, v22
    v_add_f32 v108, 1.0, v108
    v_add_f32 v109, 1.0, v109
    v_add_f32 v110, 1.0, v110
    v_add_f32 v111, 1.0, v111
    v_cvt_pk_bf16_f32 v22, v108, v109
    v_lshlrev_b32 v108, 16, v22
    v_and_b32 v109, 0xffff0000, v22
    v_cvt_pk_bf16_f32 v22, v110, v111
    v_lshlrev_b32 v110, 16, v22
    v_and_b32 v111, 0xffff0000, v22
    v_mul_f32 v28, v28, v108
    v_mul_f32 v29, v29, v109
    v_mul_f32 v30, v30, v110
    v_mul_f32 v31, v31, v111
    v_cvt_pk_bf16_f32 v22, v28, v29
    v_lshlrev_b32 v28, 16, v22
    v_and_b32 v29, 0xffff0000, v22
    v_cvt_pk_bf16_f32 v22, v30, v31
    v_lshlrev_b32 v30, 16, v22
    v_and_b32 v31, 0xffff0000, v22
    v_add_f32 v28, v28, v100
    v_add_f32 v29, v29, v101
    v_add_f32 v30, v30, v102
    v_add_f32 v31, v31, v103
    v_cvt_pk_bf16_f32 v24, v28, v29
    v_cvt_pk_bf16_f32 v25, v30, v31
    v_mul_u32_u24 v4, 160, v2
    v_lshlrev_b32 v5, 3, v3
    v_add_u32 v4, v4, v5
    v_add_u32 v4, 131712, v4
    s_mov_b32 exec_hi, 0xff
    ds_write_b64 v4, v[24:25]
    s_mov_b32 exec_hi, -1
    s_waitcnt lgkmcnt(0)
    s_waitcnt lgkmcnt(0)
    ds_read_b128 v[8:11], v94
    ds_read_b128 v[12:15], v94 offset:64
    ds_read_b64 v[16:17], v95 offset:128
    s_mov_b32 s96, 0
SP_27:
    ds_read_b32 v161, v160 offset:28
    s_add_u32 s96, s96, 1
    s_waitcnt lgkmcnt(0)
    v_readfirstlane_b32 s97, v161
    s_nop 1
    s_cmp_ge_u32 s97, 1
    s_nop 0
    s_cbranch_scc1 SD_28
    s_cmp_gt_u32 s96, 1048576
    s_cbranch_scc1 SD_28
    s_sleep 1
    s_branch SP_27
SD_28:
    s_mov_b32 s75, s97
    v_mfma_f32_16x16x32_bf16 v[32:35], v[8:11], v[64:67], 0
    v_mfma_f32_16x16x16_bf16 v[48:51], v[16:17], v[72:73], 0
    v_mfma_f32_16x16x32_bf16 v[32:35], v[12:15], v[68:71], v[32:35]
    ds_read_b64_tr_b16 v[64:65], v159 offset:128
    ds_read_b64_tr_b16 v[66:67], v159 offset:1664
    ds_read_b64_tr_b16 v[68:69], v159 offset:12416
    ds_read_b64_tr_b16 v[70:71], v159 offset:13952
    ds_read_b64_tr_b16 v[72:73], v99 offset:128
    v_mfma_f32_16x16x32_bf16 v[36:39], v[8:11], v[74:77], 0
    v_mfma_f32_16x16x16_bf16 v[52:55], v[16:17], v[82:83], 0
    v_mfma_f32_16x16x32_bf16 v[36:39], v[12:15], v[78:81], v[36:39]
    ds_read_b64_tr_b16 v[74:75], v156 offset:256
    ds_read_b64_tr_b16 v[76:77], v156 offset:1792
    ds_read_b64_tr_b16 v[78:79], v156 offset:12544
    ds_read_b64_tr_b16 v[80:81], v156 offset:14080
    ds_read_b64_tr_b16 v[82:83], v96 offset:256
    v_mfma_f32_16x16x32_bf16 v[40:43], v[8:11], v[84:87], 0
    v_mfma_f32_16x16x16_bf16 v[56:59], v[16:17], v[92:93], 0
    v_mfma_f32_16x16x32_bf16 v[40:43], v[12:15], v[88:91], v[40:43]
    s_waitcnt lgkmcnt(10)
    ds_read_b64_tr_b16 v[84:85], v157 offset:256
    ds_read_b64_tr_b16 v[86:87], v157 offset:1792
    ds_read_b64_tr_b16 v[88:89], v157 offset:12544
    ds_read_b64_tr_b16 v[90:91], v157 offset:14080
    ds_read_b64_tr_b16 v[92:93], v97 offset:256
    v_mfma_f32_16x16x32_bf16 v[44:47], v[8:11], v[116:119], 0
    v_mfma_f32_16x16x16_bf16 v[60:63], v[16:17], v[124:125], 0
    v_mfma_f32_16x16x32_bf16 v[44:47], v[12:15], v[120:123], v[44:47]
    s_waitcnt lgkmcnt(10)
    ds_read_b64_tr_b16 v[116:117], v158 offset:256
    ds_read_b64_tr_b16 v[118:119], v158 offset:1792
    ds_read_b64_tr_b16 v[120:121], v158 offset:12544
    ds_read_b64_tr_b16 v[122:123], v158 offset:14080
    ds_read_b64_tr_b16 v[124:125], v98 offset:256
    v_cndmask_b32 v18, v32, v36, s[48:49]
    v_cndmask_b32 v24, v48, v52, s[48:49]
    v_cndmask_b32 v18, v18, v40, s[50:51]
    v_cndmask_b32 v24, v24, v56, s[50:51]
    v_cndmask_b32 v18, v18, v44, s[52:53]
    v_cndmask_b32 v24, v24, v60, s[52:53]
    v_add_f32 v18, v18, v24
    v_cndmask_b32 v19, v33, v37, s[48:49]
    v_cndmask_b32 v25, v49, v53, s[48:49]
    v_cndmask_b32 v19, v19, v41, s[50:51]
    v_cndmask_b32 v25, v25, v57, s[50:51]
    v_cndmask_b32 v19, v19, v45, s[52:53]
    v_cndmask_b32 v25, v25, v61, s[52:53]
    v_add_f32 v19, v19, v25
    v_bfi_b32 v18, v162, v163, v18
    v_bfi_b32 v19, v162, v163, v19
    s_cmp_eq_u32 s75, 2
    s_cbranch_scc1 QF_29
    buffer_store_dword v18, v1, s[36:39], s44 offen offset:512 sc1
    buffer_store_dword v19, v1, s[36:39], s44 offen offset:1280 sc1
    s_branch QD_30
QF_29:
    buffer_store_dword v18, v1, s[36:39], s44 offen offset:512
    buffer_store_dword v19, v1, s[36:39], s44 offen offset:1280
QD_30:
    v_mfma_f32_16x16x32_bf16 v[32:35], v[8:11], v[126:129], 0
    v_mfma_f32_16x16x16_bf16 v[48:51], v[16:17], v[134:135], 0
    v_mfma_f32_16x16x32_bf16 v[32:35], v[12:15], v[130:133], v[32:35]
    s_waitcnt lgkmcnt(10)
    ds_read_b64_tr_b16 v[126:127], v159 offset:256
    ds_read_b64_tr_b16 v[128:129], v159 offset:1792
    ds_read_b64_tr_b16 v[130:131], v159 offset:12544
    ds_read_b64_tr_b16 v[132:133], v159 offset:14080
    ds_read_b64_tr_b16 v[134:135], v99 offset:256
    v_mfma_f32_16x16x32_bf16 v[36:39], v[8:11], v[136:139], 0
    v_mfma_f32_16x16x16_bf16 v[52:55], v[16:17], v[144:145], 0
    v_mfma_f32_16x16x32_bf16 v[36:39], v[12:15], v[140:143], v[36:39]
    v_mfma_f32_16x16x32_bf16 v[40:43], v[8:11], v[146:149], 0
    v_mfma_f32_16x16x16_bf16 v[56:59], v[16:17], v[154:155], 0
    v_mfma_f32_16x16x32_bf16 v[40:43], v[12:15], v[150:153], v[40:43]
    s_waitcnt lgkmcnt(10)
    v_mfma_f32_16x16x32_bf16 v[44:47], v[8:11], v[64:67], 0
    v_mfma_f32_16x16x16_bf16 v[60:63], v[16:17], v[72:73], 0
    v_mfma_f32_16x16x32_bf16 v[44:47], v[12:15], v[68:71], v[44:47]
    s_nop 0
    v_cndmask_b32 v18, v32, v36, s[48:49]
    v_cndmask_b32 v24, v48, v52, s[48:49]
    s_nop 0
    v_cndmask_b32 v18, v18, v40, s[50:51]
    v_cndmask_b32 v24, v24, v56, s[50:51]
    s_nop 1
    v_cndmask_b32 v18, v18, v44, s[52:53]
    v_cndmask_b32 v24, v24, v60, s[52:53]
    v_add_f32 v18, v18, v24
    v_cndmask_b32 v19, v33, v37, s[48:49]
    v_cndmask_b32 v25, v49, v53, s[48:49]
    v_cndmask_b32 v19, v19, v41, s[50:51]
    v_cndmask_b32 v25, v25, v57, s[50:51]
    v_cndmask_b32 v19, v19, v45, s[52:53]
    v_cndmask_b32 v25, v25, v61, s[52:53]
    v_add_f32 v19, v19, v25
    v_bfi_b32 v18, v162, v163, v18
    v_bfi_b32 v19, v162, v163, v19
    s_cmp_eq_u32 s75, 2
    s_cbranch_scc1 QF_31
    buffer_store_dword v18, v1, s[36:39], s44 offen offset:768 sc1
    buffer_store_dword v19, v1, s[36:39], s44 offen offset:1536 sc1
    s_branch QD_32
QF_31:
    buffer_store_dword v18, v1, s[36:39], s44 offen offset:768
    buffer_store_dword v19, v1, s[36:39], s44 offen offset:1536
QD_32:
    s_waitcnt lgkmcnt(10)
    v_mfma_f32_16x16x32_bf16 v[32:35], v[8:11], v[74:77], 0
    v_mfma_f32_16x16x16_bf16 v[48:51], v[16:17], v[82:83], 0
    v_mfma_f32_16x16x32_bf16 v[32:35], v[12:15], v[78:81], v[32:35]
    s_waitcnt lgkmcnt(10)
    v_mfma_f32_16x16x32_bf16 v[36:39], v[8:11], v[84:87], 0
    v_mfma_f32_16x16x16_bf16 v[52:55], v[16:17], v[92:93], 0
    v_mfma_f32_16x16x32_bf16 v[36:39], v[12:15], v[88:91], v[36:39]
    s_waitcnt lgkmcnt(5)
    v_mfma_f32_16x16x32_bf16 v[40:43], v[8:11], v[116:119], 0
    v_mfma_f32_16x16x16_bf16 v[56:59], v[16:17], v[124:125], 0
    v_mfma_f32_16x16x32_bf16 v[40:43], v[12:15], v[120:123], v[40:43]
    s_waitcnt lgkmcnt(0)
    v_mfma_f32_16x16x32_bf16 v[44:47], v[8:11], v[126:129], 0
    v_mfma_f32_16x16x16_bf16 v[60:63], v[16:17], v[134:135], 0
    v_mfma_f32_16x16x32_bf16 v[44:47], v[12:15], v[130:133], v[44:47]
    v_cndmask_b32 v18, v32, v36, s[48:49]
    v_cndmask_b32 v24, v48, v52, s[48:49]
    s_nop 1
    v_cndmask_b32 v18, v18, v40, s[50:51]
    v_cndmask_b32 v24, v24, v56, s[50:51]
    s_nop 1
    v_cndmask_b32 v18, v18, v44, s[52:53]
    v_cndmask_b32 v24, v24, v60, s[52:53]
    v_add_f32 v18, v18, v24
    v_cndmask_b32 v19, v33, v37, s[48:49]
    v_cndmask_b32 v25, v49, v53, s[48:49]
    v_cndmask_b32 v19, v19, v41, s[50:51]
    v_cndmask_b32 v25, v25, v57, s[50:51]
    v_cndmask_b32 v19, v19, v45, s[52:53]
    v_cndmask_b32 v25, v25, v61, s[52:53]
    v_add_f32 v19, v19, v25
    v_bfi_b32 v18, v162, v163, v18
    v_bfi_b32 v19, v162, v163, v19
    s_cmp_eq_u32 s75, 2
    s_cbranch_scc1 QF_33
    buffer_store_dword v18, v1, s[36:39], s44 offen offset:1024 sc1
    buffer_store_dword v19, v1, s[36:39], s44 offen offset:1792 sc1
    s_branch QD_34
QF_33:
    buffer_store_dword v18, v1, s[36:39], s44 offen offset:1024
    buffer_store_dword v19, v1, s[36:39], s44 offen offset:1792
QD_34:
    v_mov_b32 v161, 3
    ds_write_b32 v160, v161 offset:36
    s_lshl_b32 s6, s40, 6
    s_add_u32 s6, s6, s4
    s_lshl_b32 s84, s6, 13
    s_mul_i32 s6, s45, 768
    s_add_u32 s84, s84, s6
    v_lshlrev_b32 v4, 4, v0
    v_mov_b32 v7, 0x80000000
    v_cmp_gt_u32 vcc, 48, v0
    s_nop 1
    v_cndmask_b32 v4, v7, v4, vcc
    s_add_u32 s85, s84, 65536
    s_add_u32 s86, s85, 65536
    s_add_u32 s87, s86, 65536
    s_add_u32 s88, s87, 65536
    s_add_u32 s89, s88, 65536
    s_add_u32 s90, s89, 65536
    s_add_u32 s91, s90, 65536
    buffer_load_dwordx4 v[96:99], v4, s[36:39], s84 offen offset:512 sc1
    buffer_load_dwordx4 v[100:103], v4, s[36:39], s85 offen offset:512 sc1
    buffer_load_dwordx4 v[104:107], v4, s[36:39], s86 offen offset:512 sc1
    buffer_load_dwordx4 v[108:111], v4, s[36:39], s87 offen offset:512 sc1
    buffer_load_dwordx4 v[112:115], v4, s[36:39], s88 offen offset:512 sc1
    buffer_load_dwordx4 v[116:119], v4, s[36:39], s89 offen offset:512 sc1
    buffer_load_dwordx4 v[120:123], v4, s[36:39], s90 offen offset:512 sc1
    buffer_load_dwordx4 v[124:127], v4, s[36:39], s91 offen offset:512 sc1
    s_mov_b32 s96, 0
SL_35:
    s_add_u32 s96, s96, 1
    s_waitcnt vmcnt(0)
    v_cmp_ne_u32_sdwa s[56:57], v99, s95 src0_sel:BYTE_0 src1_sel:BYTE_0
    v_cmp_ne_u32_sdwa s[58:59], v103, s95 src0_sel:BYTE_0 src1_sel:BYTE_0
    v_cmp_ne_u32_sdwa s[60:61], v107, s95 src0_sel:BYTE_0 src1_sel:BYTE_0
    v_cmp_ne_u32_sdwa s[62:63], v111, s95 src0_sel:BYTE_0 src1_sel:BYTE_0
    v_cmp_ne_u32_sdwa s[64:65], v115, s95 src0_sel:BYTE_0 src1_sel:BYTE_0
    v_cmp_ne_u32_sdwa s[66:67], v119, s95 src0_sel:BYTE_0 src1_sel:BYTE_0
    v_cmp_ne_u32_sdwa s[72:73], v123, s95 src0_sel:BYTE_0 src1_sel:BYTE_0
    v_cmp_ne_u32_sdwa s[76:77], v127, s95 src0_sel:BYTE_0 src1_sel:BYTE_0
    s_and_b64 s[56:57], s[56:57], s[70:71]
    s_and_b64 s[58:59], s[58:59], s[70:71]
    s_and_b64 s[60:61], s[60:61], s[70:71]
    s_and_b64 s[62:63], s[62:63], s[70:71]
    s_and_b64 s[64:65], s[64:65], s[70:71]
    s_and_b64 s[66:67], s[66:67], s[70:71]
    s_and_b64 s[72:73], s[72:73], s[70:71]
    s_and_b64 s[76:77], s[76:77], s[70:71]
    s_or_b64 vcc, s[56:57], s[58:59]
    s_or_b64 vcc, vcc, s[60:61]
    s_or_b64 vcc, vcc, s[62:63]
    s_or_b64 vcc, vcc, s[64:65]
    s_or_b64 vcc, vcc, s[66:67]
    s_or_b64 vcc, vcc, s[72:73]
    s_or_b64 vcc, vcc, s[76:77]
    s_cbranch_scc0 SE_36
    s_cmp_gt_u32 s96, 32768
    s_cbranch_scc1 SE_36
    s_cmp_lg_u64 s[56:57], 0
    s_cbranch_scc0 SK_37
    buffer_load_dwordx4 v[96:99], v4, s[36:39], s84 offen offset:512 sc1
SK_37:
    s_cmp_lg_u64 s[58:59], 0
    s_cbranch_scc0 SK_38
    buffer_load_dwordx4 v[100:103], v4, s[36:39], s85 offen offset:512 sc1
SK_38:
    s_cmp_lg_u64 s[60:61], 0
    s_cbranch_scc0 SK_39
    buffer_load_dwordx4 v[104:107], v4, s[36:39], s86 offen offset:512 sc1
SK_39:
    s_cmp_lg_u64 s[62:63], 0
    s_cbranch_scc0 SK_40
    buffer_load_dwordx4 v[108:111], v4, s[36:39], s87 offen offset:512 sc1
SK_40:
    s_cmp_lg_u64 s[64:65], 0
    s_cbranch_scc0 SK_41
    buffer_load_dwordx4 v[112:115], v4, s[36:39], s88 offen offset:512 sc1
SK_41:
    s_cmp_lg_u64 s[66:67], 0
    s_cbranch_scc0 SK_42
    buffer_load_dwordx4 v[116:119], v4, s[36:39], s89 offen offset:512 sc1
SK_42:
    s_cmp_lg_u64 s[72:73], 0
    s_cbranch_scc0 SK_43
    buffer_load_dwordx4 v[120:123], v4, s[36:39], s90 offen offset:512 sc1
SK_43:
    s_cmp_lg_u64 s[76:77], 0
    s_cbranch_scc0 SK_44
    buffer_load_dwordx4 v[124:127], v4, s[36:39], s91 offen offset:512 sc1
SK_44:
    s_branch SL_35
SE_36:
    v_and_b32 v99, 0xffffff00, v99
    v_and_b32 v103, 0xffffff00, v103
    v_and_b32 v107, 0xffffff00, v107
    v_and_b32 v111, 0xffffff00, v111
    v_and_b32 v115, 0xffffff00, v115
    v_and_b32 v119, 0xffffff00, v119
    v_and_b32 v123, 0xffffff00, v123
    v_and_b32 v127, 0xffffff00, v127
    v_pk_add_f32 v[8:9], v[96:97], v[100:101]
    v_pk_add_f32 v[12:13], v[104:105], v[108:109]
    v_pk_add_f32 v[16:17], v[112:113], v[116:117]
    v_pk_add_f32 v[20:21], v[120:121], v[124:125]
    v_pk_add_f32 v[10:11], v[98:99], v[102:103]
    v_pk_add_f32 v[14:15], v[106:107], v[110:111]
    v_pk_add_f32 v[18:19], v[114:115], v[118:119]
    v_pk_add_f32 v[22:23], v[122:123], v[126:127]
    v_pk_add_f32 v[8:9], v[8:9], v[12:13]
    v_pk_add_f32 v[16:17], v[16:17], v[20:21]
    v_pk_add_f32 v[10:11], v[10:11], v[14:15]
    v_pk_add_f32 v[18:19], v[18:19], v[22:23]
    v_pk_add_f32 v[8:9], v[8:9], v[16:17]
    v_pk_add_f32 v[10:11], v[10:11], v[18:19]
    v_cvt_pk_bf16_f32 v24, v8, v9
    v_cvt_pk_bf16_f32 v25, v10, v11
    v_lshlrev_b32 v4, 3, v0
    v_add_u32 v4, 132032, v4
    s_mov_b32 exec_hi, 0xffff
    ds_write_b64 v4, v[24:25]
    s_mov_b32 exec_hi, -1
    s_waitcnt lgkmcnt(0)
    v_mov_b32 v161, 1
    ds_write_b32 v160, v161 offset:16
    s_waitcnt vmcnt(0)
    s_branch L_PV
L_POST:
    s_setprio 3
    s_sub_u32 s54, s3, 10
    v_mov_b32 v9, 0x80000000
    v_mov_b32 v10, 0x80000000
    v_mov_b32 v11, 0x80000000
    v_mov_b32 v12, 0x80000000
    v_mov_b32 v13, 0x80000000
    v_mov_b32 v14, 0x80000000
    v_mov_b32 v15, 0x80000000
    v_mov_b32 v16, 0x80000000
    v_mov_b32 v17, 0x80000000
    v_mov_b32 v18, 0x80000000
    v_mov_b32 v19, 0x80000000
    v_mov_b32 v20, 0x80000000
    v_mov_b32 v21, 0x80000000
    v_mov_b32 v22, 0x80000000
    v_mov_b32 v23, 0x80000000
    v_mov_b32 v24, 0x80000000
    v_mov_b32 v25, 0x80000000
    v_mov_b32 v26, 0x80000000
    v_mov_b32 v27, 0x80000000
    v_mov_b32 v28, 0x80000000
    v_mov_b32 v29, 0x80000000
    s_waitcnt lgkmcnt(0)
    s_barrier
    s_mov_b32 s36, s34
    s_mov_b32 s37, s35
    s_mov_b32 s38, 2097280
    s_mov_b32 s39, 0x00020000
    s_cmp_eq_u32 s54, 0
    s_cbranch_scc0 L_POST_W11
    s_mov_b32 s78, 5
    s_cmp_lt_u32 s5, 30
    s_cbranch_scc1 L_POST_R0
    s_mov_b32 s78, 6
L_POST_R0:
    v_mov_b32 v2, 2097152
    buffer_load_dword v47, v2, s[36:39], 0 offen sc1
    s_getreg_b32 s76, hwreg(HW_REG_XCC_ID)
    s_and_b32 s76, s76, 15
    s_waitcnt vmcnt(0)
    v_add_u32 v47, 1, v47
    v_and_b32 v3, 0xff, v47
    v_or_b32 v4, 0x100, v3
    ds_write_b32 v160, v47 offset:40
    ds_write_b32 v160, v4 offset:24
    s_lshl_b32 s6, s76, 8
    v_or_b32 v3, s6, v3
    v_mov_b32 v4, 0x80000000
    v_cmp_eq_u32 vcc, 0, v0
    s_nop 1
    v_cndmask_b32 v4, v4, 0, vcc
    buffer_store_dword v3, v4, s[36:39], s44 offen offset:2880 sc1
    s_branch L_POST_A
L_POST_W11:
    s_mov_b32 s78, 7
    s_cmp_lt_u32 s5, 30
    s_cbranch_scc1 L_POST_R1
    s_mov_b32 s78, 8
L_POST_R1:
L_POST_A:
    s_mov_b32 s96, 0
SP_45:
    ds_read_b32 v161, v160 offset:24
    s_add_u32 s96, s96, 1
    s_waitcnt lgkmcnt(0)
    v_readfirstlane_b32 s97, v161
    s_nop 1
    s_cmp_ge_u32 s97, 256
    s_nop 0
    s_cbranch_scc1 SD_46
    s_cmp_gt_u32 s96, 1048576
    s_cbranch_scc1 SD_46
    s_sleep 1
    s_branch SP_45
SD_46:
    s_and_b32 s95, s97, 0xff
    v_mov_b32 v163, s95
    s_cmp_eq_u32 s78, 6
    s_cbranch_scc1 L_POST_XC
    s_cmp_eq_u32 s78, 8
    s_cbranch_scc1 L_POST_Q
    s_branch L_MSTAGE
L_POST_M:
    s_cmp_eq_u32 s78, 5
    s_cbranch_scc0 L_POST_ADDR
L_POST_XC:
    v_lshlrev_b32 v48, 16, v0
    s_lshl_b32 s6, s4, 13
    v_add_u32 v48, s6, v48
    v_mov_b32 v49, 0x80000000
    v_cmp_gt_u32 vcc, 32, v0
    s_nop 1
    v_cndmask_b32 v48, v49, v48, vcc
    s_mov_b32 s76, -1
    s_mov_b32 s77, 0
    s_mov_b32 s96, 0
PL_47:
    buffer_load_dword v50, v48, s[36:39], 0 offen offset:2880 sc1
    s_add_u32 s96, s96, 1
    s_waitcnt vmcnt(0)
    v_xor_b32 v164, s95, v50
    v_and_b32 v164, 0xff, v164
    v_cmp_ne_u32 vcc, 0, v164
    s_nop 1
    s_and_b64 vcc, vcc, s[76:77]
    s_nop 0
    s_cbranch_scc0 PD_48
    s_cmp_gt_u32 s96, 32768
    s_cbranch_scc1 PD_48
    s_branch PL_47
PD_48:
    s_getreg_b32 s6, hwreg(HW_REG_XCC_ID)
    s_and_b32 s6, s6, 15
    v_lshrrev_b32 v50, 8, v50
    v_cmp_ne_u32 vcc, s6, v50
    s_nop 1
    s_and_b64 vcc, vcc, s[76:77]
    s_cselect_b32 s6, 1, 2
    v_mov_b32 v161, s6
    ds_write_b32 v160, v161 offset:28
    s_cmp_eq_u32 s78, 6
    s_cbranch_scc1 L_POST_Q
L_POST_ADDR:
    v_lshrrev_b32 v1, 4, v0
    v_and_b32 v2, 15, v0
    v_lshlrev_b32 v3, 4, v2
    s_lshl_b32 s55, s54, 8
    v_lshl_add_u32 v4, v2, 2, v1
    v_lshlrev_b32 v4, 1, v4
    s_lshl_b32 s6, s54, 7
    v_add_u32 v9, s6, v4
    v_lshlrev_b32 v10, 1, v0
    v_add_u32 v10, s6, v10
    v_add_u32 v10, 134976, v10
    s_add_u32 s6, s54, 30
    s_lshl_b32 s6, s6, 3
    s_add_u32 s6, s6, s4
    s_lshl_b32 s6, s6, 13
    s_lshl_b32 s7, s43, 8
    s_add_u32 s6, s6, s7
    v_lshlrev_b32 v22, 2, v0
    v_add_u32 v22, s6, v22
    s_mul_i32 s6, s42, 80
    s_add_u32 s6, s6, s4
    s_lshl_b32 s6, s6, 13
    s_add_u32 s7, s6, s55
    v_mov_b32 v7, 0x80000000
    v_add_u32 v5, 0, v1
    v_cmp_gt_u32 vcc, 10, v5
    v_lshlrev_b32 v5, 16, v5
    v_add3_u32 v5, v5, v3, s7
    v_cndmask_b32 v23, v7, v5, vcc
    v_add_u32 v5, 4, v1
    v_cmp_gt_u32 vcc, 10, v5
    v_lshlrev_b32 v5, 16, v5
    v_add3_u32 v5, v5, v3, s7
    v_cndmask_b32 v24, v7, v5, vcc
    v_add_u32 v5, 8, v1
    v_cmp_gt_u32 vcc, 10, v5
    v_lshlrev_b32 v5, 16, v5
    v_add3_u32 v5, v5, v3, s7
    v_cndmask_b32 v25, v7, v5, vcc
    s_lshl_b32 s6, s42, 8
    v_lshlrev_b32 v5, 2, v0
    v_add_u32 v5, s6, v5
    v_mul_u32_u24 v6, 342, v5
    v_lshrrev_b32 v6, 16, v6
    v_mul_u32_u24 v7, 192, v6
    v_sub_u32 v5, v5, v7
    v_lshlrev_b32 v5, 2, v5
    v_lshlrev_b32 v6, 3, v6
    s_lshl_b32 s6, s54, 2
    v_add_u32 v6, s6, v6
    v_lshlrev_b32 v6, 3, v6
    v_add_u32 v6, s4, v6
    v_lshlrev_b32 v26, 13, v6
    v_add_u32 v27, v26, v5
    v_lshlrev_b32 v28, 3, v0
    s_lshl_b32 s6, s54, 9
    s_add_u32 s6, s6, 133952
    v_add_u32 v28, s6, v28
    s_mov_b32 s88, 4096
    s_mov_b32 s90, -1
    s_mov_b32 s91, 0
    ds_read_b32 v5, v160 offset:40
    s_waitcnt lgkmcnt(0)
    v_readfirstlane_b32 s94, v5
    s_nop 4
L_POST_Q:
    s_add_u32 s82, s54, 1
    s_branch L_VLOAD
L_PV:
    v_lshrrev_b32 v100, 4, v0
    v_lshrrev_b32 v101, 2, v0
    v_and_b32 v101, 3, v101
    v_and_b32 v102, 3, v0
    v_lshrrev_b32 v103, 1, v101
    v_and_b32 v104, 1, v100
    v_lshlrev_b32 v104, 1, v104
    v_or_b32 v103, v103, v104
    v_lshlrev_b32 v104, 3, v100
    v_add_u32 v104, v104, v101
    v_lshlrev_b32 v105, 3, v102
    s_and_b32 s6, s3, 3
    v_xor_b32 v106, s6, v103
    v_lshlrev_b32 v106, 5, v106
    s_lshr_b32 s6, s3, 2
    s_lshl_b32 s6, s6, 7
    v_mul_u32_u24 v107, 384, v104
    v_add3_u32 v107, v107, v105, v106
    v_add_u32 v107, s6, v107
    v_add_u32 v108, 49152, v107
    v_lshlrev_b32 v109, 4, v100
    v_add_u32 v109, 133440, v109
    s_lshl_b32 s6, s3, 6
    v_lshlrev_b32 v110, 2, v0
    v_add_u32 v110, s6, v110
    v_mov_b32 v111, 0x80000000
    v_cmp_gt_u32 vcc, 16, v0
    s_nop 1
    v_cndmask_b32 v110, v111, v110, vcc
    s_mov_b32 s96, 0
    s_nop 0
SP_49:
    ds_read_b32 v161, v160 offset:20
    s_add_u32 s96, s96, 1
    s_waitcnt lgkmcnt(0)
    v_readfirstlane_b32 s97, v161
    s_nop 1
    s_cmp_ge_u32 s97, 8
    s_nop 0
    s_cbranch_scc1 SD_50
    s_cmp_gt_u32 s96, 1048576
    s_cbranch_scc1 SD_50
    s_sleep 3
    s_branch SP_49
SD_50:
    ds_read_b64 v[164:165], v160 offset:24
    v_mov_b32 v111, 132416
    ds_read_b128 v[124:127], v111 offset:0
    ds_read_b128 v[128:131], v111 offset:16
    ds_read_b128 v[132:135], v111 offset:32
    ds_read_b128 v[136:139], v111 offset:48
    ds_read_b128 v[64:67], v109 offset:0
    ds_read_b128 v[68:71], v109 offset:64
    ds_read_b128 v[72:75], v109 offset:128
    ds_read_b128 v[76:79], v109 offset:192
    ds_read_b128 v[80:83], v109 offset:256
    ds_read_b128 v[84:87], v109 offset:320
    ds_read_b128 v[88:91], v109 offset:384
    ds_read_b128 v[92:95], v109 offset:448
    s_waitcnt lgkmcnt(8)
    v_max3_f32 v148, v124, v126, v128
    v_max3_f32 v148, v148, v130, v132
    v_max3_f32 v148, v148, v134, v136
    v_max_f32 v148, v148, v138
    v_sub_f32 v140, v124, v148
    v_sub_f32 v141, v126, v148
    v_sub_f32 v142, v128, v148
    v_sub_f32 v143, v130, v148
    v_sub_f32 v144, v132, v148
    v_sub_f32 v145, v134, v148
    v_sub_f32 v146, v136, v148
    v_sub_f32 v147, v138, v148
    v_exp_f32 v140, v140
    v_exp_f32 v141, v141
    v_exp_f32 v142, v142
    v_exp_f32 v143, v143
    v_exp_f32 v144, v144
    v_exp_f32 v145, v145
    v_exp_f32 v146, v146
    v_exp_f32 v147, v147
    v_readfirstlane_b32 s97, v164
    v_readfirstlane_b32 s75, v165
    v_and_b32 v163, 0xff, v164
    s_and_b32 s95, s97, 0xff
    s_cmp_eq_u32 s3, 9
    s_nop 0
    s_cbranch_scc0 L_PV_NOML
    ds_read_b32 v150, v160 offset:40
    v_mul_f32 v149, v140, v125
    v_fma_f32 v149, v141, v127, v149
    v_fma_f32 v149, v142, v129, v149
    v_fma_f32 v149, v143, v131, v149
    v_fma_f32 v149, v144, v133, v149
    v_fma_f32 v149, v145, v135, v149
    v_fma_f32 v149, v146, v137, v149
    v_fma_f32 v149, v147, v139, v149
    v_mov_b32 v151, 0
    v_mov_b32 v152, 0x80000000
    v_cmp_eq_u32 vcc, 0, v0
    s_nop 1
    v_cndmask_b32 v152, v152, 0, vcc
    s_waitcnt lgkmcnt(0)
    s_cmp_eq_u32 s75, 2
    s_cbranch_scc1 PF_51
    buffer_store_dwordx4 v[148:151], v152, s[36:39], s44 offen offset:2816 sc1
    s_nop 0
    s_branch PE_52
PF_51:
    buffer_store_dwordx4 v[148:151], v152, s[36:39], s44 offen offset:2816
    s_nop 1
PE_52:
L_PV_NOML:
    s_cmp_eq_u32 s79, 11
    s_cbranch_scc0 L_PV_WA
    s_waitcnt vmcnt(11)
    s_branch L_PV_W1
L_PV_WA:
    s_cmp_eq_u32 s79, 10
    s_cbranch_scc0 L_PV_W0
    s_waitcnt vmcnt(10)
    s_branch L_PV_W1
L_PV_W0:
    s_cmp_eq_u32 s79, 0
    s_cbranch_scc0 L_PV_W1
    s_waitcnt vmcnt(0)
L_PV_W1:
    s_waitcnt lgkmcnt(0)
    s_barrier
    ds_read_b64_tr_b16 v[48:49], v107 offset:0
    ds_read_b64_tr_b16 v[50:51], v107 offset:1536
    ds_read_b64_tr_b16 v[52:53], v107 offset:12288
    ds_read_b64_tr_b16 v[54:55], v107 offset:13824
    ds_read_b64_tr_b16 v[56:57], v107 offset:24576
    ds_read_b64_tr_b16 v[58:59], v107 offset:26112
    ds_read_b64_tr_b16 v[60:61], v107 offset:36864
    ds_read_b64_tr_b16 v[62:63], v107 offset:38400
    ds_read_b64_tr_b16 v[112:113], v108 offset:0
    ds_read_b64_tr_b16 v[114:115], v108 offset:1536
    ds_read_b64_tr_b16 v[116:117], v108 offset:12288
    ds_read_b64_tr_b16 v[118:119], v108 offset:13824
    ds_read_b64_tr_b16 v[120:121], v108 offset:24576
    ds_read_b64_tr_b16 v[122:123], v108 offset:26112
    s_waitcnt lgkmcnt(12)
    v_mfma_f32_16x16x32_bf16 v[124:127], v[64:67], v[48:51], 0
    ds_read_b64_tr_b16 v[48:49], v108 offset:36864
    ds_read_b64_tr_b16 v[50:51], v108 offset:38400
    s_waitcnt lgkmcnt(12)
    v_mfma_f32_16x16x32_bf16 v[128:131], v[68:71], v[52:55], 0
    s_waitcnt lgkmcnt(10)
    v_mfma_f32_16x16x32_bf16 v[132:135], v[72:75], v[56:59], 0
    s_waitcnt lgkmcnt(8)
    v_mfma_f32_16x16x32_bf16 v[136:139], v[76:79], v[60:63], 0
    s_waitcnt lgkmcnt(6)
    v_mfma_f32_16x16x32_bf16 v[148:151], v[80:83], v[112:115], 0
    s_waitcnt lgkmcnt(4)
    v_mfma_f32_16x16x32_bf16 v[152:155], v[84:87], v[116:119], 0
    s_waitcnt lgkmcnt(2)
    v_mfma_f32_16x16x32_bf16 v[156:159], v[88:91], v[120:123], 0
    s_waitcnt lgkmcnt(0)
    v_mfma_f32_16x16x32_bf16 v[96:99], v[92:95], v[48:51], 0
    v_mul_f32 v106, v140, v124
    v_mul_f32 v111, v141, v128
    v_fma_f32 v106, v142, v132, v106
    v_fma_f32 v111, v143, v136, v111
    v_fma_f32 v106, v144, v148, v106
    v_fma_f32 v111, v145, v152, v111
    v_fma_f32 v106, v146, v156, v106
    s_nop 0
    v_fma_f32 v111, v147, v96, v111
    v_add_f32 v96, v106, v111
    v_bfi_b32 v96, v162, v163, v96
    s_cmp_eq_u32 s75, 2
    s_cbranch_scc1 PF_53
    buffer_store_dword v96, v110, s[36:39], s44 offen offset:2048 sc1
    s_branch PE_54
PF_53:
    buffer_store_dword v96, v110, s[36:39], s44 offen offset:2048
PE_54:
    s_cmp_eq_u32 s78, 1
    s_cbranch_scc1 L_K2
    s_cmp_eq_u32 s78, 5
    s_cbranch_scc1 L_POST2
    s_cmp_eq_u32 s78, 7
    s_cbranch_scc1 L_POST2
    s_cmp_eq_u32 s78, 2
    s_cbranch_scc1 L_HUB
    s_cmp_eq_u32 s78, 9
    s_cbranch_scc1 L_HUB
    s_cmp_eq_u32 s78, 10
    s_cbranch_scc1 L_HUB
    s_cmp_eq_u32 s78, 3
    s_cbranch_scc0 L_FIN
    s_waitcnt vmcnt(1)
    s_barrier
    s_branch L_FIN
L_K2:
    s_mul_i32 s88, s4, 3
    s_add_u32 s88, s88, s42
    s_movk_i32 s89, 0xc00
    s_cmp_eq_u32 s3, 6
    s_cselect_b32 s89, 1280, s89
    s_cselect_b32 s90, s88, s43
    s_cselect_b32 s91, s43, s88
    s_lshl_b32 s90, s90, 6
    s_mul_i32 s90, s90, s89
    s_lshl_b32 s91, s91, 7
    s_add_u32 s90, s90, s91
    s_cmp_eq_u32 s3, 4
    s_cselect_b32 s68, s20, s22
    s_cselect_b32 s69, s21, s23
    s_cmp_eq_u32 s3, 6
    s_cselect_b32 s68, s24, s68
    s_cselect_b32 s69, s25, s69
    s_mov_b32 s70, 1966080
    s_mov_b32 s71, 0x00020000
    s_sub_u32 s91, s3, 4
    s_lshl_b32 s91, s91, 13
    s_add_u32 s91, s91, 135680
    v_lshrrev_b32 v1, 3, v0
    v_and_b32 v2, 7, v0
    v_lshrrev_b32 v3, 1, v1
    v_and_b32 v3, 1, v3
    v_lshrrev_b32 v4, 1, v2
    v_xor_b32 v4, v4, v3
    v_lshlrev_b32 v4, 5, v4
    v_and_b32 v3, 1, v2
    v_lshlrev_b32 v3, 4, v3
    v_or_b32 v4, v4, v3
    v_mul_lo_u32 v72, v1, s89
    v_add_u32 v72, v72, v4
    v_xor_b32 v73, 64, v72
    s_lshl_b32 s89, s89, 3
    s_and_b32 s6, s3, 1
    s_lshl_b32 s7, s6, 1
    v_xor_b32 v106, s7, v103
    v_lshlrev_b32 v106, 5, v106
    v_lshlrev_b32 v107, 7, v104
    v_add_u32 v107, v107, v105
    v_xor_b32 v105, 32, v106
    v_add_u32 v105, v105, v107
    v_add_u32 v106, v106, v107
    s_and_b32 s7, s3, 3
    v_xor_b32 v109, s7, v103
    v_lshlrev_b32 v109, 5, v109
    v_add_u32 v107, v109, v107
    v_and_b32 v108, 1, v0
    v_lshrrev_b32 v110, 1, v100
    v_lshlrev_b32 v110, 8, v110
    v_and_b32 v111, 1, v100
    v_lshlrev_b32 v111, 6, v111
    v_and_b32 v113, 15, v0
    v_lshlrev_b32 v113, 2, v113
    v_add3_u32 v110, v110, v111, v113
    s_lshl_b32 s6, s6, 7
    v_add_u32 v110, s6, v110
    s_lshl_b32 s7, s7, 6
    s_lshr_b32 s6, s3, 2
    s_lshl_b32 s6, s6, 9
    s_add_u32 s7, s7, s6
    v_lshlrev_b32 v111, 8, v100
    v_add3_u32 v115, v111, v113, s7
    v_mov_b32 v111, 0x80000000
    v_cmp_gt_u32 vcc, 32, v0
    s_nop 1
    v_cndmask_b32 v115, v111, v115, vcc
    v_lshlrev_b32 v113, 4, v100
    v_lshlrev_b32 v112, 9, v108
    v_add_u32 v112, v112, v113
    v_add_u32 v112, 133952, v112
    v_add_u32 v114, 98304, v106
    v_add_u32 v116, 98304, v105
    s_waitcnt vmcnt(1)
    s_barrier
    s_cmp_gt_u32 s3, 1
    s_cbranch_scc1 L_K_NOWO
    ds_read_b128 v[64:67], v112 offset:0
    ds_read_b64_tr_b16 v[48:49], v114 offset:0
    ds_read_b64_tr_b16 v[50:51], v114 offset:512
    ds_read_b64_tr_b16 v[120:121], v116 offset:0
    ds_read_b64_tr_b16 v[122:123], v116 offset:512
    ds_read_b128 v[68:71], v112 offset:64
    ds_read_b64_tr_b16 v[52:53], v114 offset:4096
    ds_read_b64_tr_b16 v[54:55], v114 offset:4608
    ds_read_b64_tr_b16 v[124:125], v116 offset:4096
    ds_read_b64_tr_b16 v[126:127], v116 offset:4608
    ds_read_b128 v[72:75], v112 offset:128
    ds_read_b64_tr_b16 v[56:57], v114 offset:8192
    ds_read_b64_tr_b16 v[58:59], v114 offset:8704
    ds_read_b64_tr_b16 v[128:129], v116 offset:8192
    ds_read_b64_tr_b16 v[130:131], v116 offset:8704
    s_waitcnt lgkmcnt(10)
    v_mfma_f32_16x16x32_bf16 v[96:99], v[64:67], v[48:51], 0
    v_mfma_f32_16x16x32_bf16 v[140:143], v[64:67], v[120:123], 0
    ds_read_b128 v[76:79], v112 offset:192
    ds_read_b64_tr_b16 v[48:49], v114 offset:12288
    ds_read_b64_tr_b16 v[50:51], v114 offset:12800
    ds_read_b64_tr_b16 v[120:121], v116 offset:12288
    ds_read_b64_tr_b16 v[122:123], v116 offset:12800
    s_waitcnt lgkmcnt(10)
    v_mfma_f32_16x16x32_bf16 v[96:99], v[68:71], v[52:55], v[96:99]
    v_mfma_f32_16x16x32_bf16 v[140:143], v[68:71], v[124:127], v[140:143]
    ds_read_b128 v[80:83], v112 offset:256
    ds_read_b64_tr_b16 v[52:53], v114 offset:16384
    ds_read_b64_tr_b16 v[54:55], v114 offset:16896
    ds_read_b64_tr_b16 v[124:125], v116 offset:16384
    ds_read_b64_tr_b16 v[126:127], v116 offset:16896
    s_waitcnt lgkmcnt(10)
    v_mfma_f32_16x16x32_bf16 v[96:99], v[72:75], v[56:59], v[96:99]
    v_mfma_f32_16x16x32_bf16 v[140:143], v[72:75], v[128:131], v[140:143]
    ds_read_b128 v[84:87], v112 offset:320
    ds_read_b64_tr_b16 v[56:57], v114 offset:20480
    ds_read_b64_tr_b16 v[58:59], v114 offset:20992
    ds_read_b64_tr_b16 v[128:129], v116 offset:20480
    ds_read_b64_tr_b16 v[130:131], v116 offset:20992
    s_waitcnt lgkmcnt(10)
    v_mfma_f32_16x16x32_bf16 v[96:99], v[76:79], v[48:51], v[96:99]
    v_mfma_f32_16x16x32_bf16 v[140:143], v[76:79], v[120:123], v[140:143]
    ds_read_b128 v[88:91], v112 offset:384
    ds_read_b64_tr_b16 v[48:49], v114 offset:24576
    ds_read_b64_tr_b16 v[50:51], v114 offset:25088
    ds_read_b64_tr_b16 v[120:121], v116 offset:24576
    ds_read_b64_tr_b16 v[122:123], v116 offset:25088
    s_waitcnt lgkmcnt(10)
    v_mfma_f32_16x16x32_bf16 v[96:99], v[80:83], v[52:55], v[96:99]
    v_mfma_f32_16x16x32_bf16 v[140:143], v[80:83], v[124:127], v[140:143]
    ds_read_b128 v[92:95], v112 offset:448
    ds_read_b64_tr_b16 v[52:53], v114 offset:28672
    ds_read_b64_tr_b16 v[54:55], v114 offset:29184
    ds_read_b64_tr_b16 v[124:125], v116 offset:28672
    ds_read_b64_tr_b16 v[126:127], v116 offset:29184
    s_waitcnt lgkmcnt(10)
    v_mfma_f32_16x16x32_bf16 v[96:99], v[84:87], v[56:59], v[96:99]
    v_mfma_f32_16x16x32_bf16 v[140:143], v[84:87], v[128:131], v[140:143]
    s_waitcnt lgkmcnt(5)
    v_mfma_f32_16x16x32_bf16 v[96:99], v[88:91], v[48:51], v[96:99]
    v_mfma_f32_16x16x32_bf16 v[140:143], v[88:91], v[120:123], v[140:143]
    s_waitcnt lgkmcnt(0)
    v_mfma_f32_16x16x32_bf16 v[96:99], v[92:95], v[52:55], v[96:99]
    v_mfma_f32_16x16x32_bf16 v[140:143], v[92:95], v[124:127], v[140:143]
    s_nop 7
    v_cndmask_b32 v96, v96, v140, s[48:49]
    v_cndmask_b32 v96, v96, v97, s[50:51]
    v_cndmask_b32 v96, v96, v141, s[52:53]
    v_bfi_b32 v96, v162, v163, v96
    buffer_store_dword v96, v110, s[36:39], s44 offen offset:3072 sc1
    s_waitcnt vmcnt(0)
    v_mov_b32 v161, 1
    s_mov_b64 exec, 1
    ds_add_u32 v160, v161 offset:48
    s_mov_b64 exec, -1
    s_branch L_K_GU
L_K_NOWO:
    s_cmp_lt_u32 s3, 4
    s_cbranch_scc1 L_K_GU
    s_cmp_eq_u32 s3, 7
    s_cbranch_scc1 L_K_GU
    s_mov_b32 s96, 0
SP_55:
    ds_read_b32 v161, v160 offset:48
    s_add_u32 s96, s96, 1
    s_waitcnt lgkmcnt(0)
    v_readfirstlane_b32 s97, v161
    s_nop 1
    s_cmp_ge_u32 s97, 2
    s_nop 0
    s_cbranch_scc1 SD_56
    s_cmp_gt_u32 s96, 1048576
    s_cbranch_scc1 SD_56
    s_sleep 1
    s_branch SP_55
SD_56:
    s_add_u32 m0, s91, 0
    s_nop 0
    buffer_load_dwordx4 v72, s[68:71], s90 offen nt lds
    s_add_u32 s90, s90, s89
    s_add_u32 m0, s91, 1024
    s_nop 0
    buffer_load_dwordx4 v73, s[68:71], s90 offen nt lds
    s_add_u32 s90, s90, s89
    s_add_u32 m0, s91, 2048
    s_nop 0
    buffer_load_dwordx4 v72, s[68:71], s90 offen nt lds
    s_add_u32 s90, s90, s89
    s_add_u32 m0, s91, 3072
    s_nop 0
    buffer_load_dwordx4 v73, s[68:71], s90 offen nt lds
    s_add_u32 s90, s90, s89
    s_add_u32 m0, s91, 4096
    s_nop 0
    buffer_load_dwordx4 v72, s[68:71], s90 offen nt lds
    s_add_u32 s90, s90, s89
    s_add_u32 m0, s91, 5120
    s_nop 0
    buffer_load_dwordx4 v73, s[68:71], s90 offen nt lds
    s_add_u32 s90, s90, s89
    s_add_u32 m0, s91, 6144
    s_nop 0
    buffer_load_dwordx4 v72, s[68:71], s90 offen nt lds
    s_add_u32 s90, s90, s89
    s_add_u32 m0, s91, 7168
    s_nop 0
    buffer_load_dwordx4 v73, s[68:71], s90 offen nt lds
    s_waitcnt vmcnt(0)
L_K_GU:
    s_lshr_b32 s6, s3, 2
    s_lshl_b32 s7, s6, 13
    s_add_u32 s7, s7, 135680
    v_add_u32 v114, s7, v107
    v_lshlrev_b32 v112, 7, v108
    v_add_u32 v112, v112, v113
    v_add_u32 v117, 135232, v112
    v_add_u32 v112, 134976, v112
    s_add_u32 s6, s44, 4096
    s_barrier
    ds_read_b128 v[64:67], v112
    ds_read_b128 v[68:71], v112 offset:64
    ds_read_b64_tr_b16 v[48:49], v114 offset:0
    ds_read_b64_tr_b16 v[50:51], v114 offset:512
    ds_read_b64_tr_b16 v[52:53], v114 offset:4096
    ds_read_b64_tr_b16 v[54:55], v114 offset:4608
    s_waitcnt lgkmcnt(2)
    v_mfma_f32_16x16x32_bf16 v[96:99], v[64:67], v[48:51], 0
    s_waitcnt lgkmcnt(0)
    v_mfma_f32_16x16x32_bf16 v[96:99], v[68:71], v[52:55], v[96:99]
    s_nop 7
    v_cndmask_b32 v96, v96, v97, s[48:49]
    v_bfi_b32 v96, v162, v163, v96
    s_cmp_eq_u32 s75, 2
    s_cbranch_scc1 PF_57
    buffer_store_dword v96, v115, s[36:39], s6 offen sc1
    s_branch PE_58
PF_57:
    buffer_store_dword v96, v115, s[36:39], s6 offen
PE_58:
    s_cmp_gt_u32 s3, 1
    s_cbranch_scc1 L_FIN
    v_add_u32 v114, 152064, v106
    v_add_u32 v116, 152064, v105
    ds_read_b64_tr_b16 v[48:49], v114 offset:0
    ds_read_b64_tr_b16 v[50:51], v114 offset:512
    ds_read_b64_tr_b16 v[52:53], v114 offset:4096
    ds_read_b64_tr_b16 v[54:55], v114 offset:4608
    ds_read_b64_tr_b16 v[120:121], v116 offset:0
    ds_read_b64_tr_b16 v[122:123], v116 offset:512
    ds_read_b64_tr_b16 v[124:125], v116 offset:4096
    ds_read_b64_tr_b16 v[126:127], v116 offset:4608
    s_barrier
    ds_read_b128 v[64:67], v117
    ds_read_b128 v[68:71], v117 offset:64
    s_waitcnt lgkmcnt(1)
    v_mfma_f32_16x16x32_bf16 v[96:99], v[64:67], v[48:51], 0
    v_mfma_f32_16x16x32_bf16 v[140:143], v[64:67], v[120:123], 0
    s_waitcnt lgkmcnt(0)
    v_mfma_f32_16x16x32_bf16 v[96:99], v[68:71], v[52:55], v[96:99]
    v_mfma_f32_16x16x32_bf16 v[140:143], v[68:71], v[124:127], v[140:143]
    s_nop 7
    v_cndmask_b32 v96, v96, v140, s[48:49]
    v_cndmask_b32 v96, v96, v97, s[50:51]
    v_cndmask_b32 v96, v96, v141, s[52:53]
    v_bfi_b32 v96, v162, v163, v96
    buffer_store_dword v96, v110, s[36:39], s44 offen offset:3584 sc1
    s_branch L_FIN
L_POST2:
    s_mov_b32 s84, 0
    s_mov_b32 s85, 65536
    s_mov_b32 s86, 131072
    s_mov_b32 s87, 196608
    buffer_load_dwordx4 v[64:67], v27, s[36:39], s84 offen offset:2048 sc1
    buffer_load_dwordx4 v[68:71], v27, s[36:39], s85 offen offset:2048 sc1
    buffer_load_dwordx4 v[72:75], v27, s[36:39], s86 offen offset:2048 sc1
    buffer_load_dwordx4 v[76:79], v27, s[36:39], s87 offen offset:2048 sc1
    buffer_load_dwordx4 v[80:83], v26, s[36:39], s84 offen offset:2816 sc1
    buffer_load_dwordx4 v[84:87], v26, s[36:39], s85 offen offset:2816 sc1
    buffer_load_dwordx4 v[88:91], v26, s[36:39], s86 offen offset:2816 sc1
    buffer_load_dwordx4 v[92:95], v26, s[36:39], s87 offen offset:2816 sc1
    s_mov_b32 s96, 0
SL_59:
    s_add_u32 s96, s96, 1
    s_waitcnt vmcnt(0)
    v_cmp_ne_u32_sdwa s[64:65], v67, s95 src0_sel:BYTE_0 src1_sel:BYTE_0
    v_cmp_ne_u32_sdwa s[66:67], v71, s95 src0_sel:BYTE_0 src1_sel:BYTE_0
    v_cmp_ne_u32_sdwa s[68:69], v75, s95 src0_sel:BYTE_0 src1_sel:BYTE_0
    v_cmp_ne_u32_sdwa s[70:71], v79, s95 src0_sel:BYTE_0 src1_sel:BYTE_0
    v_cmp_ne_u32 s[72:73], s94, v82
    v_cmp_ne_u32 s[76:77], s94, v86
    v_cmp_ne_u32 s[80:81], s94, v90
    v_cmp_ne_u32 s[82:83], s94, v94
    s_or_b64 vcc, s[64:65], s[66:67]
    s_or_b64 vcc, vcc, s[68:69]
    s_or_b64 vcc, vcc, s[70:71]
    s_or_b64 vcc, vcc, s[72:73]
    s_or_b64 vcc, vcc, s[76:77]
    s_or_b64 vcc, vcc, s[80:81]
    s_or_b64 vcc, vcc, s[82:83]
    s_cbranch_scc0 SE_60
    s_cmp_gt_u32 s96, 32768
    s_cbranch_scc1 SE_60
    s_cmp_lg_u64 s[64:65], 0
    s_cbranch_scc0 SK_61
    buffer_load_dwordx4 v[64:67], v27, s[36:39], s84 offen offset:2048 sc1
SK_61:
    s_cmp_lg_u64 s[66:67], 0
    s_cbranch_scc0 SK_62
    buffer_load_dwordx4 v[68:71], v27, s[36:39], s85 offen offset:2048 sc1
SK_62:
    s_cmp_lg_u64 s[68:69], 0
    s_cbranch_scc0 SK_63
    buffer_load_dwordx4 v[72:75], v27, s[36:39], s86 offen offset:2048 sc1
SK_63:
    s_cmp_lg_u64 s[70:71], 0
    s_cbranch_scc0 SK_64
    buffer_load_dwordx4 v[76:79], v27, s[36:39], s87 offen offset:2048 sc1
SK_64:
    s_cmp_lg_u64 s[72:73], 0
    s_cbranch_scc0 SK_65
    buffer_load_dwordx4 v[80:83], v26, s[36:39], s84 offen offset:2816 sc1
SK_65:
    s_cmp_lg_u64 s[76:77], 0
    s_cbranch_scc0 SK_66
    buffer_load_dwordx4 v[84:87], v26, s[36:39], s85 offen offset:2816 sc1
SK_66:
    s_cmp_lg_u64 s[80:81], 0
    s_cbranch_scc0 SK_67
    buffer_load_dwordx4 v[88:91], v26, s[36:39], s86 offen offset:2816 sc1
SK_67:
    s_cmp_lg_u64 s[82:83], 0
    s_cbranch_scc0 SK_68
    buffer_load_dwordx4 v[92:95], v26, s[36:39], s87 offen offset:2816 sc1
SK_68:
    s_branch SL_59
SE_60:
    v_and_b32 v67, 0xffffff00, v67
    v_and_b32 v71, 0xffffff00, v71
    v_and_b32 v75, 0xffffff00, v75
    v_and_b32 v79, 0xffffff00, v79
    v_max3_f32 v48, v80, v84, v88
    v_max_f32 v48, v48, v92
    v_sub_f32 v50, v80, v48
    v_sub_f32 v51, v84, v48
    v_sub_f32 v52, v88, v48
    v_sub_f32 v53, v92, v48
    v_exp_f32 v50, v50
    v_exp_f32 v51, v51
    v_exp_f32 v52, v52
    v_exp_f32 v53, v53
    v_mul_f32 v49, v50, v81
    v_mul_f32 v56, v50, v64
    v_mul_f32 v57, v50, v65
    v_fma_f32 v49, v51, v85, v49
    v_mul_f32 v58, v50, v66
    v_mul_f32 v59, v50, v67
    v_fma_f32 v49, v52, v89, v49
    v_fma_f32 v56, v51, v68, v56
    v_fma_f32 v57, v51, v69, v57
    v_fma_f32 v58, v51, v70, v58
    v_fma_f32 v59, v51, v71, v59
    v_fma_f32 v49, v53, v93, v49
    v_fma_f32 v56, v52, v72, v56
    v_fma_f32 v57, v52, v73, v57
    v_fma_f32 v58, v52, v74, v58
    v_fma_f32 v59, v52, v75, v59
    v_rcp_f32 v49, v49
    v_fma_f32 v56, v53, v76, v56
    v_fma_f32 v57, v53, v77, v57
    v_fma_f32 v58, v53, v78, v58
    v_fma_f32 v59, v53, v79, v59
    v_mul_f32 v56, v56, v49
    v_mul_f32 v57, v57, v49
    v_mul_f32 v58, v58, v49
    v_mul_f32 v59, v59, v49
    v_cvt_pk_bf16_f32 v60, v56, v57
    v_cvt_pk_bf16_f32 v61, v58, v59
    ds_write_b64 v28, v[60:61]
    s_waitcnt lgkmcnt(0)
    s_barrier
    s_mov_b32 s96, 0
PL_69:
    buffer_load_dword v64, v22, s[36:39], 0 offen offset:3072 sc1
    s_add_u32 s96, s96, 1
    s_waitcnt vmcnt(0)
    v_xor_b32 v164, s95, v64
    v_and_b32 v164, 0xff, v164
    v_cmp_ne_u32 vcc, 0, v164
    s_nop 1
    s_and_b64 vcc, vcc, exec
    s_nop 0
    s_cbranch_scc0 PD_70
    s_cmp_gt_u32 s96, 32768
    s_cbranch_scc1 PD_70
    s_sleep 1
    s_branch PL_69
PD_70:
    v_lshrrev_b32 v64, 16, v64
    ds_write_b16 v10, v64
    s_waitcnt lgkmcnt(0)
    s_barrier
    buffer_load_dwordx4 v[80:83], v23, s[36:39], s88 offen offset:0 sc1
    buffer_load_dwordx4 v[84:87], v24, s[36:39], s88 offen offset:0 sc1
    buffer_load_dwordx4 v[88:91], v25, s[36:39], s88 offen offset:0 sc1
    buffer_load_dwordx4 v[92:95], v23, s[36:39], s88 offen offset:512 sc1
    buffer_load_dwordx4 v[96:99], v24, s[36:39], s88 offen offset:512 sc1
    buffer_load_dwordx4 v[100:103], v25, s[36:39], s88 offen offset:512 sc1
    s_mov_b32 s96, 0
SL_71:
    s_add_u32 s96, s96, 1
    s_waitcnt vmcnt(0)
    v_cmp_ne_u32_sdwa s[64:65], v83, s95 src0_sel:BYTE_0 src1_sel:BYTE_0
    v_cmp_ne_u32_sdwa s[66:67], v87, s95 src0_sel:BYTE_0 src1_sel:BYTE_0
    v_cmp_ne_u32_sdwa s[68:69], v91, s95 src0_sel:BYTE_0 src1_sel:BYTE_0
    v_cmp_ne_u32_sdwa s[70:71], v95, s95 src0_sel:BYTE_0 src1_sel:BYTE_0
    v_cmp_ne_u32_sdwa s[72:73], v99, s95 src0_sel:BYTE_0 src1_sel:BYTE_0
    v_cmp_ne_u32_sdwa s[76:77], v103, s95 src0_sel:BYTE_0 src1_sel:BYTE_0
    s_and_b64 s[68:69], s[68:69], s[90:91]
    s_nop 0
    s_and_b64 s[76:77], s[76:77], s[90:91]
    s_or_b64 vcc, s[64:65], s[66:67]
    s_or_b64 vcc, vcc, s[68:69]
    s_or_b64 vcc, vcc, s[70:71]
    s_or_b64 vcc, vcc, s[72:73]
    s_or_b64 vcc, vcc, s[76:77]
    s_cbranch_scc0 SE_72
    s_cmp_gt_u32 s96, 32768
    s_cbranch_scc1 SE_72
    s_cmp_lg_u64 s[64:65], 0
    s_cbranch_scc0 SK_73
    buffer_load_dwordx4 v[80:83], v23, s[36:39], s88 offen offset:0 sc1
SK_73:
    s_cmp_lg_u64 s[66:67], 0
    s_cbranch_scc0 SK_74
    buffer_load_dwordx4 v[84:87], v24, s[36:39], s88 offen offset:0 sc1
SK_74:
    s_cmp_lg_u64 s[68:69], 0
    s_cbranch_scc0 SK_75
    buffer_load_dwordx4 v[88:91], v25, s[36:39], s88 offen offset:0 sc1
SK_75:
    s_cmp_lg_u64 s[70:71], 0
    s_cbranch_scc0 SK_76
    buffer_load_dwordx4 v[92:95], v23, s[36:39], s88 offen offset:512 sc1
SK_76:
    s_cmp_lg_u64 s[72:73], 0
    s_cbranch_scc0 SK_77
    buffer_load_dwordx4 v[96:99], v24, s[36:39], s88 offen offset:512 sc1
SK_77:
    s_cmp_lg_u64 s[76:77], 0
    s_cbranch_scc0 SK_78
    buffer_load_dwordx4 v[100:103], v25, s[36:39], s88 offen offset:512 sc1
SK_78:
    s_branch SL_71
SE_72:
    v_and_b32 v83, 0xffffff00, v83
    v_and_b32 v87, 0xffffff00, v87
    v_and_b32 v91, 0xffffff00, v91
    v_and_b32 v95, 0xffffff00, v95
    v_and_b32 v99, 0xffffff00, v99
    v_and_b32 v103, 0xffffff00, v103
    v_pk_add_f32 v[64:65], v[80:81], v[84:85]
    v_pk_add_f32 v[66:67], v[82:83], v[86:87]
    v_pk_add_f32 v[64:65], v[64:65], v[88:89]
    v_pk_add_f32 v[66:67], v[66:67], v[90:91]
    v_pk_add_f32 v[68:69], v[92:93], v[96:97]
    v_pk_add_f32 v[70:71], v[94:95], v[98:99]
    v_pk_add_f32 v[68:69], v[68:69], v[100:101]
    v_pk_add_f32 v[70:71], v[70:71], v[102:103]
    v_permlane32_swap_b32 v64, v66
    v_permlane32_swap_b32 v65, v67
    v_add_f32 v64, v64, v66
    v_add_f32 v65, v65, v67
    s_nop 1
    v_permlane16_swap_b32 v64, v65
    v_add_f32 v64, v64, v65
    v_permlane32_swap_b32 v68, v70
    v_permlane32_swap_b32 v69, v71
    v_add_f32 v68, v68, v70
    v_add_f32 v69, v69, v71
    s_nop 1
    v_permlane16_swap_b32 v68, v69
    v_add_f32 v68, v68, v69
    v_cvt_pk_bf16_f32 v72, v64, v68
    v_lshlrev_b32 v64, 16, v72
    v_and_b32 v68, 0xffff0000, v72
    v_mul_f32 v72, v64, v64
    v_mul_f32 v72, 0x3d372713, v72
    v_add_f32 v72, 1.0, v72
    v_mul_f32 v72, v72, v64
    v_mul_f32 v72, 0xc0135761, v72
    v_exp_f32 v72, v72
    s_nop 0
    v_add_f32 v72, 1.0, v72
    v_rcp_f32 v72, v72
    s_nop 0
    v_mul_f32 v64, v64, v72
    v_cvt_pk_bf16_f32 v64, v64, v64
    v_lshlrev_b32 v64, 16, v64
    v_mul_f32 v64, v64, v68
    v_cvt_pk_bf16_f32 v64, v64, v64
    v_add_u32 v73, 135232, v9
    ds_write_b16 v73, v64
    s_waitcnt lgkmcnt(0)
    s_barrier
    s_branch L_FIN
L_HUB:
    s_mov_b32 s56, s8
    s_mov_b32 s57, s9
    s_mov_b32 s58, 2560
    s_mov_b32 s59, 0x00020000
    s_mov_b32 s60, s30
    s_mov_b32 s61, s31
    s_mov_b32 s62, 2560
    s_mov_b32 s63, 0x00020000
    s_setprio 3
    s_sub_u32 s54, s5, 30
    v_lshrrev_b32 v1, 4, v0
    v_and_b32 v2, 15, v0
    v_lshlrev_b32 v3, 4, v2
    s_lshl_b32 s55, s54, 8
    v_lshl_add_u32 v4, v2, 2, v1
    s_lshl_b32 s6, s3, 8
    v_lshlrev_b32 v9, 2, v4
    v_add_u32 v9, s6, v9
    v_lshlrev_b32 v4, 1, v4
    s_mul_i32 s6, s54, 1280
    s_lshl_b32 s7, s3, 7
    s_add_u32 s6, s6, s7
    v_add_u32 v11, s6, v4
    buffer_load_ushort v8, v11, s[56:59], 0 offen
    buffer_load_ushort v10, v11, s[60:63], 0 offen
    s_add_u32 s6, s3, 20
    s_lshl_b32 s6, s6, 3
    s_add_u32 s6, s6, 0
    s_lshl_b32 s6, s6, 13
    s_add_u32 s6, s6, s55
    v_lshlrev_b32 v5, 13, v1
    v_add3_u32 v12, v5, v3, s6
    s_add_u32 s6, s3, 0
    s_lshl_b32 s6, s6, 3
    s_add_u32 s6, s6, 4
    s_lshl_b32 s6, s6, 13
    s_add_u32 s6, s6, s55
    v_lshlrev_b32 v5, 13, v1
    v_add3_u32 v13, v5, v3, s6
    s_add_u32 s6, s3, 10
    s_lshl_b32 s6, s6, 3
    s_add_u32 s6, s6, 4
    s_lshl_b32 s6, s6, 13
    s_add_u32 s6, s6, s55
    v_lshlrev_b32 v5, 13, v1
    v_add3_u32 v14, v5, v3, s6
    s_add_u32 s6, s3, 20
    s_lshl_b32 s6, s6, 3
    s_add_u32 s6, s6, 4
    s_lshl_b32 s6, s6, 13
    s_add_u32 s6, s6, s55
    v_lshlrev_b32 v5, 13, v1
    v_add3_u32 v15, v5, v3, s6
    v_add_u32 v5, 0, v1
    v_mul_u32_u24 v6, 86, v5
    v_lshrrev_b32 v6, 8, v6
    v_mul_u32_u24 v7, 3, v6
    v_sub_u32 v5, v5, v7
    v_mul_u32_u24 v5, 10, v5
    v_add_u32 v5, s3, v5
    v_lshlrev_b32 v5, 3, v5
    v_add_u32 v5, v5, v6
    v_lshlrev_b32 v5, 13, v5
    v_add3_u32 v16, v5, v3, s55
    v_add_u32 v5, 4, v1
    v_mul_u32_u24 v6, 86, v5
    v_lshrrev_b32 v6, 8, v6
    v_mul_u32_u24 v7, 3, v6
    v_sub_u32 v5, v5, v7
    v_mul_u32_u24 v5, 10, v5
    v_add_u32 v5, s3, v5
    v_lshlrev_b32 v5, 3, v5
    v_add_u32 v5, v5, v6
    v_lshlrev_b32 v5, 13, v5
    v_add3_u32 v17, v5, v3, s55
    v_add_u32 v5, 8, v1
    v_mul_u32_u24 v6, 86, v5
    v_lshrrev_b32 v6, 8, v6
    v_mul_u32_u24 v7, 3, v6
    v_sub_u32 v5, v5, v7
    v_mul_u32_u24 v5, 10, v5
    v_add_u32 v5, s3, v5
    v_lshlrev_b32 v5, 3, v5
    v_add_u32 v5, v5, v6
    v_lshlrev_b32 v5, 13, v5
    v_add3_u32 v18, v5, v3, s55
    v_add_u32 v5, 12, v1
    v_mul_u32_u24 v6, 86, v5
    v_lshrrev_b32 v6, 8, v6
    v_mul_u32_u24 v7, 3, v6
    v_sub_u32 v5, v5, v7
    v_mul_u32_u24 v5, 10, v5
    v_add_u32 v5, s3, v5
    v_lshlrev_b32 v5, 3, v5
    v_add_u32 v5, v5, v6
    v_lshlrev_b32 v5, 13, v5
    v_add3_u32 v19, v5, v3, s55
    v_add_u32 v5, 16, v1
    v_mul_u32_u24 v6, 86, v5
    v_lshrrev_b32 v6, 8, v6
    v_mul_u32_u24 v7, 3, v6
    v_sub_u32 v5, v5, v7
    v_mul_u32_u24 v5, 10, v5
    v_add_u32 v5, s3, v5
    v_lshlrev_b32 v5, 3, v5
    v_add_u32 v5, v5, v6
    v_lshlrev_b32 v5, 13, v5
    v_add3_u32 v20, v5, v3, s55
    v_add_u32 v5, 20, v1
    v_mul_u32_u24 v6, 86, v5
    v_lshrrev_b32 v6, 8, v6
    v_mul_u32_u24 v7, 3, v6
    v_sub_u32 v5, v5, v7
    v_mul_u32_u24 v5, 10, v5
    v_add_u32 v5, s3, v5
    v_lshlrev_b32 v5, 3, v5
    v_add_u32 v5, v5, v6
    v_lshlrev_b32 v5, 13, v5
    v_add3_u32 v21, v5, v3, s55
    v_lshrrev_b32 v5, 5, v0
    v_lshlrev_b32 v5, 2, v5
    s_lshl_b32 s6, s3, 3
    s_add_u32 s6, s6, 132416
    v_add_u32 v29, s6, v5
    v_lshlrev_b32 v28, 3, v2
    v_add_u32 v28, 132416, v28
    s_mov_b32 s92, 0x03ff03ff
    s_mov_b32 s93, 0x03ff03ff
    buffer_load_dwordx4 v[48:51], v12, s[36:39], 0 offen offset:0 sc1
    buffer_load_dwordx4 v[52:55], v13, s[36:39], 0 offen offset:0 sc1
    buffer_load_dwordx4 v[56:59], v14, s[36:39], 0 offen offset:0 sc1
    buffer_load_dwordx4 v[60:63], v15, s[36:39], 0 offen offset:0 sc1
    s_mov_b32 s96, 0
SL_79:
    s_add_u32 s96, s96, 1
    s_waitcnt vmcnt(0)
    v_cmp_ne_u32_sdwa s[64:65], v51, s95 src0_sel:BYTE_0 src1_sel:BYTE_0
    v_cmp_ne_u32_sdwa s[66:67], v55, s95 src0_sel:BYTE_0 src1_sel:BYTE_0
    v_cmp_ne_u32_sdwa s[68:69], v59, s95 src0_sel:BYTE_0 src1_sel:BYTE_0
    v_cmp_ne_u32_sdwa s[70:71], v63, s95 src0_sel:BYTE_0 src1_sel:BYTE_0
    s_or_b64 vcc, s[64:65], s[66:67]
    s_or_b64 vcc, vcc, s[68:69]
    s_or_b64 vcc, vcc, s[70:71]
    s_nop 0
    s_cbranch_scc0 SE_80
    s_cmp_gt_u32 s96, 32768
    s_cbranch_scc1 SE_80
    s_cmp_lg_u64 s[64:65], 0
    s_cbranch_scc0 SK_81
    buffer_load_dwordx4 v[48:51], v12, s[36:39], 0 offen offset:0 sc1
SK_81:
    s_cmp_lg_u64 s[66:67], 0
    s_cbranch_scc0 SK_82
    buffer_load_dwordx4 v[52:55], v13, s[36:39], 0 offen offset:0 sc1
SK_82:
    s_cmp_lg_u64 s[68:69], 0
    s_cbranch_scc0 SK_83
    buffer_load_dwordx4 v[56:59], v14, s[36:39], 0 offen offset:0 sc1
SK_83:
    s_cmp_lg_u64 s[70:71], 0
    s_cbranch_scc0 SK_84
    buffer_load_dwordx4 v[60:63], v15, s[36:39], 0 offen offset:0 sc1
SK_84:
    s_branch SL_79
SE_80:
    v_and_b32 v51, 0xffffff00, v51
    v_and_b32 v55, 0xffffff00, v55
    v_and_b32 v59, 0xffffff00, v59
    v_and_b32 v63, 0xffffff00, v63
    v_permlane32_swap_b32 v48, v50
    v_permlane32_swap_b32 v49, v51
    v_add_f32 v48, v48, v50
    v_add_f32 v49, v49, v51
    s_nop 1
    v_permlane16_swap_b32 v48, v49
    v_add_f32 v48, v48, v49
    v_permlane32_swap_b32 v52, v54
    v_permlane32_swap_b32 v53, v55
    v_add_f32 v52, v52, v54
    v_add_f32 v53, v53, v55
    s_nop 1
    v_permlane16_swap_b32 v52, v53
    v_add_f32 v52, v52, v53
    v_permlane32_swap_b32 v56, v58
    v_permlane32_swap_b32 v57, v59
    v_add_f32 v56, v56, v58
    v_add_f32 v57, v57, v59
    s_nop 1
    v_permlane16_swap_b32 v56, v57
    v_add_f32 v56, v56, v57
    v_permlane32_swap_b32 v60, v62
    v_permlane32_swap_b32 v61, v63
    v_add_f32 v60, v60, v62
    v_add_f32 v61, v61, v63
    s_nop 1
    v_permlane16_swap_b32 v60, v61
    v_add_f32 v60, v60, v61
    v_mov_b32 v32, v48
    v_mov_b32 v33, v52
    v_mov_b32 v34, v56
    v_mov_b32 v35, v60
    v_cvt_pk_bf16_f32 v40, v32, v33
    v_lshlrev_b32 v32, 16, v40
    v_and_b32 v33, 0xffff0000, v40
    v_cvt_pk_bf16_f32 v40, v34, v35
    v_lshlrev_b32 v34, 16, v40
    v_and_b32 v35, 0xffff0000, v40
    v_add_f32 v34, 1.0, v34
    v_cvt_pk_bf16_f32 v34, v34, v34
    v_lshlrev_b32 v34, 16, v34
    v_lshlrev_b32 v30, 16, v8
    buffer_load_dwordx4 v[112:115], v16, s[36:39], 0 offen offset:3072 sc1
    buffer_load_dwordx4 v[116:119], v17, s[36:39], 0 offen offset:3072 sc1
    buffer_load_dwordx4 v[120:123], v18, s[36:39], 0 offen offset:3072 sc1
    buffer_load_dwordx4 v[124:127], v19, s[36:39], 0 offen offset:3072 sc1
    buffer_load_dwordx4 v[128:131], v20, s[36:39], 0 offen offset:3072 sc1
    buffer_load_dwordx4 v[132:135], v21, s[36:39], 0 offen offset:3072 sc1
    s_mov_b32 s96, 0
SL_85:
    s_add_u32 s96, s96, 1
    s_waitcnt vmcnt(0)
    v_cmp_ne_u32_sdwa s[64:65], v115, s95 src0_sel:BYTE_0 src1_sel:BYTE_0
    v_cmp_ne_u32_sdwa s[66:67], v119, s95 src0_sel:BYTE_0 src1_sel:BYTE_0
    v_cmp_ne_u32_sdwa s[68:69], v123, s95 src0_sel:BYTE_0 src1_sel:BYTE_0
    v_cmp_ne_u32_sdwa s[70:71], v127, s95 src0_sel:BYTE_0 src1_sel:BYTE_0
    v_cmp_ne_u32_sdwa s[72:73], v131, s95 src0_sel:BYTE_0 src1_sel:BYTE_0
    v_cmp_ne_u32_sdwa s[76:77], v135, s95 src0_sel:BYTE_0 src1_sel:BYTE_0
    s_or_b64 vcc, s[64:65], s[66:67]
    s_or_b64 vcc, vcc, s[68:69]
    s_or_b64 vcc, vcc, s[70:71]
    s_or_b64 vcc, vcc, s[72:73]
    s_or_b64 vcc, vcc, s[76:77]
    s_cbranch_scc0 SE_86
    s_cmp_gt_u32 s96, 32768
    s_cbranch_scc1 SE_86
    s_cmp_lg_u64 s[64:65], 0
    s_cbranch_scc0 SK_87
    buffer_load_dwordx4 v[112:115], v16, s[36:39], 0 offen offset:3072 sc1
SK_87:
    s_cmp_lg_u64 s[66:67], 0
    s_cbranch_scc0 SK_88
    buffer_load_dwordx4 v[116:119], v17, s[36:39], 0 offen offset:3072 sc1
SK_88:
    s_cmp_lg_u64 s[68:69], 0
    s_cbranch_scc0 SK_89
    buffer_load_dwordx4 v[120:123], v18, s[36:39], 0 offen offset:3072 sc1
SK_89:
    s_cmp_lg_u64 s[70:71], 0
    s_cbranch_scc0 SK_90
    buffer_load_dwordx4 v[124:127], v19, s[36:39], 0 offen offset:3072 sc1
SK_90:
    s_cmp_lg_u64 s[72:73], 0
    s_cbranch_scc0 SK_91
    buffer_load_dwordx4 v[128:131], v20, s[36:39], 0 offen offset:3072 sc1
SK_91:
    s_cmp_lg_u64 s[76:77], 0
    s_cbranch_scc0 SK_92
    buffer_load_dwordx4 v[132:135], v21, s[36:39], 0 offen offset:3072 sc1
SK_92:
    s_branch SL_85
SE_86:
    v_and_b32 v115, 0xffffff00, v115
    v_and_b32 v119, 0xffffff00, v119
    v_and_b32 v123, 0xffffff00, v123
    v_and_b32 v127, 0xffffff00, v127
    v_and_b32 v131, 0xffffff00, v131
    v_and_b32 v135, 0xffffff00, v135
    v_pk_add_f32 v[64:65], v[112:113], v[116:117]
    v_pk_add_f32 v[68:69], v[120:121], v[124:125]
    v_pk_add_f32 v[72:73], v[128:129], v[132:133]
    v_pk_add_f32 v[66:67], v[114:115], v[118:119]
    v_pk_add_f32 v[70:71], v[122:123], v[126:127]
    v_pk_add_f32 v[74:75], v[130:131], v[134:135]
    v_pk_add_f32 v[64:65], v[64:65], v[68:69]
    v_pk_add_f32 v[66:67], v[66:67], v[70:71]
    v_pk_add_f32 v[64:65], v[64:65], v[72:73]
    v_pk_add_f32 v[66:67], v[66:67], v[74:75]
    s_nop 1
    v_permlane32_swap_b32 v64, v66
    v_permlane32_swap_b32 v65, v67
    v_add_f32 v64, v64, v66
    v_add_f32 v65, v65, v67
    s_nop 1
    v_permlane16_swap_b32 v64, v65
    v_add_f32 v64, v64, v65
    v_cvt_pk_bf16_f32 v64, v64, v64
    v_lshlrev_b32 v64, 16, v64
    v_mul_f32 v64, v32, v64
    v_cvt_pk_bf16_f32 v64, v64, v64
    v_lshlrev_b32 v64, 16, v64
    v_add_f32 v30, v30, v64
    v_cvt_pk_bf16_f32 v30, v30, v30
    v_lshlrev_b32 v30, 16, v30
    v_mul_f32 v65, v30, v30
    v_mov_b32 v64, v30
    s_nop 1
    v_add_f32_dpp v64, v64, v64 row_ror:8 row_mask:0xf bank_mask:0xf
    v_add_f32_dpp v65, v65, v65 row_ror:8 row_mask:0xf bank_mask:0xf
    s_nop 0
    v_add_f32_dpp v64, v64, v64 row_ror:4 row_mask:0xf bank_mask:0xf
    v_add_f32_dpp v65, v65, v65 row_ror:4 row_mask:0xf bank_mask:0xf
    s_nop 0
    v_add_f32_dpp v64, v64, v64 row_ror:2 row_mask:0xf bank_mask:0xf
    v_add_f32_dpp v65, v65, v65 row_ror:2 row_mask:0xf bank_mask:0xf
    s_nop 0
    v_add_f32_dpp v64, v64, v64 row_ror:1 row_mask:0xf bank_mask:0xf
    v_add_f32_dpp v65, v65, v65 row_ror:1 row_mask:0xf bank_mask:0xf
    s_nop 1
    v_permlane32_swap_b32 v64, v65
    v_add_f32 v64, v64, v65
    v_mov_b32 v65, v64
    s_nop 1
    v_permlane16_swap_b32 v64, v65
    v_add_f32 v64, v64, v65
    s_mov_b32 exec_lo, 1
    s_mov_b32 exec_hi, 1
    ds_write_b32 v29, v64
    s_mov_b64 exec, -1
    s_waitcnt lgkmcnt(0)
    s_barrier
    ds_read_b64 v[68:69], v28
    s_waitcnt lgkmcnt(0)
    v_cndmask_b32 v68, 0, v68, s[92:93]
    v_cndmask_b32 v69, 0, v69, s[92:93]
    s_nop 0
    v_add_f32_dpp v68, v68, v68 row_ror:8 row_mask:0xf bank_mask:0xf
    v_add_f32_dpp v69, v69, v69 row_ror:8 row_mask:0xf bank_mask:0xf
    s_nop 0
    v_add_f32_dpp v68, v68, v68 row_ror:4 row_mask:0xf bank_mask:0xf
    v_add_f32_dpp v69, v69, v69 row_ror:4 row_mask:0xf bank_mask:0xf
    s_nop 0
    v_add_f32_dpp v68, v68, v68 row_ror:2 row_mask:0xf bank_mask:0xf
    v_add_f32_dpp v69, v69, v69 row_ror:2 row_mask:0xf bank_mask:0xf
    s_nop 0
    v_add_f32_dpp v68, v68, v68 row_ror:1 row_mask:0xf bank_mask:0xf
    v_add_f32_dpp v69, v69, v69 row_ror:1 row_mask:0xf bank_mask:0xf
    v_mul_f32 v68, 0x3acccccd, v68
    v_mul_f32 v69, 0x3acccccd, v69
    v_fma_f32 v69, -v68, v68, v69
    v_max_f32 v69, 0, v69
    v_cvt_pk_bf16_f32 v70, v68, v69
    v_lshlrev_b32 v68, 16, v70
    v_and_b32 v69, 0xffff0000, v70
    v_add_f32 v69, 0x3727c5ac, v69
    v_cvt_pk_bf16_f32 v69, v69, v69
    v_lshlrev_b32 v69, 16, v69
    v_sqrt_f32 v69, v69
    s_nop 0
    v_cvt_pk_bf16_f32 v69, v69, v69
    v_lshlrev_b32 v69, 16, v69
    v_rcp_f32 v71, v69
    v_sub_f32 v64, v30, v68
    v_cvt_pk_bf16_f32 v64, v64, v64
    v_lshlrev_b32 v64, 16, v64
    v_mul_f32 v72, v64, v71
    v_fma_f32 v70, -v72, v69, v64
    v_fma_f32 v72, v70, v71, v72
    v_cvt_pk_bf16_f32 v72, v72, v72
    v_lshlrev_b32 v72, 16, v72
    v_mul_f32 v72, v72, v34
    v_cvt_pk_bf16_f32 v72, v72, v72
    v_lshlrev_b32 v72, 16, v72
    v_add_f32 v72, v72, v33
    v_cvt_pk_bf16_f32 v72, v72, v72
    v_lshlrev_b32 v72, 16, v72
    v_or_b32 v72, v72, v163
    s_cmp_eq_u32 s75, 2
    s_cbranch_scc1 PF_93
    buffer_store_dword v72, v9, s[36:39], s44 offen offset:3072 sc1
    s_branch PE_94
PF_93:
    buffer_store_dword v72, v9, s[36:39], s44 offen offset:3072
PE_94:
    s_and_b32 s6, s3, 7
    s_cmp_eq_u32 s6, s4
    s_cbranch_scc0 L_FIN
    buffer_load_dwordx4 v[112:115], v16, s[36:39], 0 offen offset:3584 sc1
    buffer_load_dwordx4 v[116:119], v17, s[36:39], 0 offen offset:3584 sc1
    buffer_load_dwordx4 v[120:123], v18, s[36:39], 0 offen offset:3584 sc1
    buffer_load_dwordx4 v[124:127], v19, s[36:39], 0 offen offset:3584 sc1
    buffer_load_dwordx4 v[128:131], v20, s[36:39], 0 offen offset:3584 sc1
    buffer_load_dwordx4 v[132:135], v21, s[36:39], 0 offen offset:3584 sc1
    s_mov_b32 s96, 0
SL_95:
    s_add_u32 s96, s96, 1
    s_waitcnt vmcnt(0)
    v_cmp_ne_u32_sdwa s[64:65], v115, s95 src0_sel:BYTE_0 src1_sel:BYTE_0
    v_cmp_ne_u32_sdwa s[66:67], v119, s95 src0_sel:BYTE_0 src1_sel:BYTE_0
    v_cmp_ne_u32_sdwa s[68:69], v123, s95 src0_sel:BYTE_0 src1_sel:BYTE_0
    v_cmp_ne_u32_sdwa s[70:71], v127, s95 src0_sel:BYTE_0 src1_sel:BYTE_0
    v_cmp_ne_u32_sdwa s[72:73], v131, s95 src0_sel:BYTE_0 src1_sel:BYTE_0
    v_cmp_ne_u32_sdwa s[76:77], v135, s95 src0_sel:BYTE_0 src1_sel:BYTE_0
    s_or_b64 vcc, s[64:65], s[66:67]
    s_or_b64 vcc, vcc, s[68:69]
    s_or_b64 vcc, vcc, s[70:71]
    s_or_b64 vcc, vcc, s[72:73]
    s_or_b64 vcc, vcc, s[76:77]
    s_cbranch_scc0 SE_96
    s_cmp_gt_u32 s96, 32768
    s_cbranch_scc1 SE_96
    s_cmp_lg_u64 s[64:65], 0
    s_cbranch_scc0 SK_97
    buffer_load_dwordx4 v[112:115], v16, s[36:39], 0 offen offset:3584 sc1
SK_97:
    s_cmp_lg_u64 s[66:67], 0
    s_cbranch_scc0 SK_98
    buffer_load_dwordx4 v[116:119], v17, s[36:39], 0 offen offset:3584 sc1
SK_98:
    s_cmp_lg_u64 s[68:69], 0
    s_cbranch_scc0 SK_99
    buffer_load_dwordx4 v[120:123], v18, s[36:39], 0 offen offset:3584 sc1
SK_99:
    s_cmp_lg_u64 s[70:71], 0
    s_cbranch_scc0 SK_100
    buffer_load_dwordx4 v[124:127], v19, s[36:39], 0 offen offset:3584 sc1
SK_100:
    s_cmp_lg_u64 s[72:73], 0
    s_cbranch_scc0 SK_101
    buffer_load_dwordx4 v[128:131], v20, s[36:39], 0 offen offset:3584 sc1
SK_101:
    s_cmp_lg_u64 s[76:77], 0
    s_cbranch_scc0 SK_102
    buffer_load_dwordx4 v[132:135], v21, s[36:39], 0 offen offset:3584 sc1
SK_102:
    s_branch SL_95
SE_96:
    v_and_b32 v115, 0xffffff00, v115
    v_and_b32 v119, 0xffffff00, v119
    v_and_b32 v123, 0xffffff00, v123
    v_and_b32 v127, 0xffffff00, v127
    v_and_b32 v131, 0xffffff00, v131
    v_and_b32 v135, 0xffffff00, v135
    v_pk_add_f32 v[64:65], v[112:113], v[116:117]
    v_pk_add_f32 v[68:69], v[120:121], v[124:125]
    v_pk_add_f32 v[72:73], v[128:129], v[132:133]
    v_pk_add_f32 v[66:67], v[114:115], v[118:119]
    v_pk_add_f32 v[70:71], v[122:123], v[126:127]
    v_pk_add_f32 v[74:75], v[130:131], v[134:135]
    v_pk_add_f32 v[64:65], v[64:65], v[68:69]
    v_pk_add_f32 v[66:67], v[66:67], v[70:71]
    v_pk_add_f32 v[64:65], v[64:65], v[72:73]
    v_pk_add_f32 v[66:67], v[66:67], v[74:75]
    s_nop 1
    v_permlane32_swap_b32 v64, v66
    v_permlane32_swap_b32 v65, v67
    v_add_f32 v64, v64, v66
    v_add_f32 v65, v65, v67
    s_nop 1
    v_permlane16_swap_b32 v64, v65
    v_add_f32 v64, v64, v65
    v_cvt_pk_bf16_f32 v64, v64, v64
    v_lshlrev_b32 v64, 16, v64
    v_mul_f32 v64, v35, v64
    v_cvt_pk_bf16_f32 v64, v64, v64
    v_lshlrev_b32 v64, 16, v64
    v_add_f32 v64, v30, v64
    v_cvt_pk_bf16_f32 v64, v64, v64
    buffer_store_short v64, v11, s[60:63], 0 offen
    s_or_b32 s6, s54, s3
    s_cmp_eq_u32 s6, 0
    s_cbranch_scc0 L_NOEPOCH
    ds_read_b32 v47, v160 offset:40
    v_mov_b32 v2, 2097152
    s_waitcnt lgkmcnt(0)
    s_mov_b64 exec, 1
    buffer_store_dword v47, v2, s[36:39], 0 offen sc1
    s_mov_b64 exec, -1
L_NOEPOCH:
L_FIN:
L_END:
    s_endpgm
L_CODE_END:
L_PAD_START:
    .fill ((1024 - ((L_PAD_START - adaLN_cond__sliding_block_cached__geglu_ffn__decode_kernel) % 1024)) % 1024) / 4, 4, 0xbf810000
L_PAD_END:

.section .rodata,"a"
.p2align 6
.amdhsa_kernel adaLN_cond__sliding_block_cached__geglu_ffn__decode_kernel
  .amdhsa_next_free_vgpr 168
  .amdhsa_next_free_sgpr 102
  .amdhsa_accum_offset 168
  .amdhsa_group_segment_fixed_size 0
  .amdhsa_kernarg_size 112
  .amdhsa_user_sgpr_count 2
  .amdhsa_user_sgpr_kernarg_segment_ptr 1
  .amdhsa_system_sgpr_workgroup_id_x 1
  .amdhsa_float_denorm_mode_32 3
.end_amdhsa_kernel
```
